```python
import torch

def _softmax(x, axis=-1):
    return torch.softmax(x, dim=axis)
def _gelu(x):
    return torch.nn.functional.gelu(x, approximate="tanh")
def _silu(x):
    return torch.nn.functional.silu(x)
def _sigmoid(x):
    return torch.sigmoid(x)
def _layernorm(x, axis=-1, eps=1e-5):
    m = x.mean(dim=axis, keepdim=True)
    v = x.var(dim=axis, keepdim=True, unbiased=False)
    return (x - m) / torch.sqrt(v + eps)
def _scatter_add(tgt, idx, src, axis=0):
    return tgt.clone().index_add_(axis, idx, src)
def _segment_sum(src, seg, n):
    out = torch.zeros((n,) + src.shape[1:], dtype=src.dtype)
    return out.index_add_(0, seg, src)
def _pad(x, pw):
    flat = tuple(v for pair in reversed(pw) for v in pair)
    return torch.nn.functional.pad(x, flat)

kernel_name = 'gated_mix__linear_attn_block__glu_gated_swiglu__prompt'

def setup_inputs():

    _w = (lambda a: (lambda t: t.to(torch.bfloat16) if t.is_floating_point() else t)(torch.as_tensor(a)))
    def _A_setup():
        B, S, D = 1, 2048, 448
        return {
            "x": _w((lambda *s: torch.randn(*s, dtype=torch.bfloat16) * 0.05)(B, S, D)),
            "wqkv": _w((lambda *s: torch.randn(*s, dtype=torch.bfloat16) * 0.8)(D, 3 * D)),
            "wo": _w((lambda *s: torch.randn(*s, dtype=torch.bfloat16) * 0.05)(D, D)),
        }
    _A_in = _A_setup()

    def _B_setup():
        B, S, D, F = 1, 2048, 448, 1792
        return {
            "x": _w((lambda *s: torch.randn(*s, dtype=torch.bfloat16) * 0.05)(B, S, D)),
            "w1": _w((lambda *s: torch.randn(*s, dtype=torch.bfloat16) * 1.6)(D, F) * (2.0 / D) ** 0.5),
            "w3": _w((lambda *s: torch.randn(*s, dtype=torch.bfloat16) * 1.6)(D, F) * (2.0 / D) ** 0.5),
            "w2": _w((lambda *s: torch.randn(*s, dtype=torch.bfloat16) * 1.6)(F, D) * (2.0 / F) ** 0.5),
        }
    _B_in = _B_setup()

    return {
        "A_x": _A_in["x"],
        "A_wqkv": _A_in["wqkv"],
        "A_wo": _A_in["wo"],
        "B_x": _B_in["x"],
        "B_w1": _B_in["w1"],
        "B_w3": _B_in["w3"],
        "B_w2": _B_in["w2"],
        "gate_w": _w((lambda *s: torch.randn(*s, dtype=torch.bfloat16) * 0.05)(448) * 16.0),
    }

def reference(A_x, A_wqkv, A_wo, B_x, B_w1, B_w3, B_w2, gate_w):
    def _A_ref(x, wqkv, wo):
        B, S, D = x.shape
        H = 16; Dh = D // H
        qkv = (lambda x, *d: x.permute(*d))((x @ wqkv).reshape(B, S, 3, H, Dh), 2, 0, 3, 1, 4)
        q, k, v = qkv[0], qkv[1], qkv[2]
        phi = lambda t: torch.where(t > 0, t + 1, torch.exp(t)) + 1e-6
        pq, pk = phi(q), phi(k)
        kv = torch.einsum("bhsd,bhse->bhde", pk, v)
        z = torch.einsum("bhsd->bhd", pk)
        num = torch.einsum("bhqd,bhde->bhqe", pq, kv)
        den = torch.einsum("bhqd,bhd->bhq", pq, z)[..., None] + 1e-6
        o = num / den
        return (lambda x, *d: x.permute(*d))(o, 0, 2, 1, 3).reshape(B, S, D) @ wo

    def _B_ref(x, w1, w3, w2):
        gate = torch.einsum("bsd,df->bsf", x, w1)
        up = torch.einsum("bsd,df->bsf", x, w3)
        h = _silu(gate) * up
        out = torch.einsum("bsf,fd->bsd", h, w2)
        return out

    x = A_x
    g = _sigmoid((x * gate_w).sum(-1, keepdims=True))
    a = _A_ref(x, A_wqkv, A_wo)
    b = _B_ref(x, B_w1, B_w3, B_w2)
    return g * a + (1 - g) * b
```

```asm
; @launch kernel=k1_kernel grid=(256,1,1) block=(512,1,1) lds=163840
; @launch kernel=k2_kernel grid=(240,1,1) block=(256,1,1) lds=65536
.amdgcn_target "amdgcn-amd-amdhsa--gfx950"
.text
.globl k1_kernel
.p2align 8
.type k1_kernel,@function
k1_kernel:
  s_cmp_ge_u32 s2, 256
  s_cbranch_scc1 K1_END
  s_load_dwordx4 s[4:7], s[0:1], 0
  s_load_dwordx2 s[8:9], s[0:1], 16
  s_load_dwordx4 s[12:15], s[0:1], 32
  s_load_dwordx4 s[16:19], s[0:1], 48
  s_load_dwordx4 s[96:99], s[0:1], 72
  v_mov_b32 v1, v0
  v_lshrrev_b32 v8, 6, v0
  v_and_b32 v0, 63, v0
  v_readfirstlane_b32 s82, v8
  s_lshr_b32 s79, s2, 6
  s_add_u32 s3, s2, s79
  s_and_b32 s3, s3, 7
  s_lshl_b32 s80, s79, 3
  s_add_u32 s77, s80, s3
  s_lshr_b32 s75, s2, 3
  s_and_b32 s75, s75, 7
  s_lshr_b32 s76, s77, 1
  s_and_b32 s74, s82, 3
  s_mov_b32 s83, 0
  s_lshl_b32 s94, s83, 7
  v_and_b32 v1, 255, v1
  s_mov_b32 s84, 0x3fb8aa3b
  s_mov_b32 s85, 0x3fb8aa3b
  s_mov_b32 s86, 0x358637bd
  s_mov_b32 s87, 0x358637bd
  s_mov_b32 s88, 0xbfb8aa3b
  s_mov_b32 s89, 0xbfb8aa3b
  s_mov_b32 s90, 0x3f800000
  s_mov_b32 s91, 0x3f800000
  s_lshl_b32 s79, s75, 8
  s_lshl_b32 s80, s74, 6
  s_add_u32 s79, s79, s80
  v_lshrrev_b32 v8, 3, v0
  v_add_u32 v8, s79, v8
  v_mul_u32_u24 v8, 896, v8
  v_and_b32 v9, 7, v0
  v_lshrrev_b32 v10, 4, v0
  v_xor_b32 v11, v9, v10
  v_lshl_add_u32 v2, v11, 4, v8
  v_xor_b32 v11, 4, v11
  v_lshl_add_u32 v3, v11, 4, v8
  s_lshl_b32 s78, s74, 13
  v_and_b32 v8, 31, v0
  v_lshrrev_b32 v9, 5, v0
  v_bfe_u32 v10, v8, 1, 3
  v_lshlrev_b32 v11, 7, v8
  v_add_u32 v11, s78, v11
  v_add_u32 v12, 0, v9
  v_xor_b32 v12, v12, v10
  v_lshl_add_u32 v73, v12, 4, v11
  v_add_u32 v12, 2, v9
  v_xor_b32 v12, v12, v10
  v_lshl_add_u32 v74, v12, 4, v11
  v_add_u32 v12, 4, v9
  v_xor_b32 v12, v12, v10
  v_lshl_add_u32 v75, v12, 4, v11
  v_add_u32 v12, 6, v9
  v_xor_b32 v12, v12, v10
  v_lshl_add_u32 v76, v12, 4, v11
  v_lshlrev_b32 v83, 4, v0
  v_bfe_u32 v10, v0, 4, 1
  v_bfe_u32 v11, v0, 2, 2
  v_and_b32 v12, 3, v0
  v_lshl_add_u32 v13, v9, 3, v11
  v_and_b32 v14, 1, v12
  v_lshlrev_b32 v14, 1, v14
  v_lshrrev_b32 v15, 1, v12
  v_add_u32 v14, v14, v15
  v_lshlrev_b32 v14, 3, v14
  s_waitcnt lgkmcnt(0)
  s_mov_b32 s24, s4
  s_and_b32 s25, s5, 0xffff
  s_mov_b32 s26, 0x1c0000
  s_mov_b32 s27, 0x00020000
  s_mov_b32 s28, s6
  s_and_b32 s29, s7, 0xffff
  s_mov_b32 s30, 0x126000
  s_mov_b32 s31, 0x00020000
  s_mov_b32 s32, s12
  s_and_b32 s33, s13, 0xffff
  s_mov_b32 s34, 0x188000
  s_mov_b32 s35, 0x00020000
  s_mov_b32 s36, s14
  s_and_b32 s37, s15, 0xffff
  s_mov_b32 s38, 0x188000
  s_mov_b32 s39, 0x00020000
  s_mov_b32 s40, s98
  s_and_b32 s41, s99, 0xffff
  s_mov_b32 s42, 0x2000000
  s_mov_b32 s43, 0x00020000
  s_mov_b32 s44, s16
  s_and_b32 s45, s17, 0xffff
  s_mov_b32 s46, 0x188000
  s_mov_b32 s47, 0x00020000
  s_mov_b32 s48, s8
  s_and_b32 s49, s9, 0xffff
  s_mov_b32 s50, 0x62000
  s_mov_b32 s51, 0x00020000
  s_mov_b32 s52, s18
  s_and_b32 s53, s19, 0xffff
  s_mov_b32 s54, 0x380
  s_mov_b32 s55, 0x00020000
  s_mov_b32 s56, s96
  s_and_b32 s57, s97, 0xffff
  s_mov_b32 s58, 0x100
  s_mov_b32 s59, 0x00020000
  s_and_b32 s79, s77, 1
  s_cmp_eq_u32 s79, 1
  s_cbranch_scc1 K1_TYPEB
  v_lshl_add_u32 v15, v10, 2, v12
  v_and_b32 v8, 6, v15
  v_cmp_eq_u32 vcc, 6, v8
  v_xor_b32 v8, 1, v15
  s_nop 0
  v_cndmask_b32 v8, v15, v8, vcc
  v_lshlrev_b32 v8, 3, v8
  v_lshl_add_u32 v8, v13, 6, v8
  v_add_u32 v77, 32768, v8
  v_cmp_eq_u32 s[22:23], 7, v15
  v_lshlrev_b32 v9, 3, v13
  v_add_u32 v9, 160128, v9
  v_cndmask_b32 v79, v77, v9, s[22:23]
  v_add_u32 v8, 256, v77
  v_add_u32 v9, 32, v9
  v_cndmask_b32 v80, v8, v9, s[22:23]
  v_mov_b32 v82, 128
  v_mov_b32 v8, 1024
  v_cndmask_b32 v81, v8, v82, s[22:23]
  v_mul_u32_u24 v8, 4128, v10
  v_lshl_add_u32 v8, v13, 6, v8
  v_add_u32 v8, v14, v8
  v_add_u32 v78, 45056, v8
  v_lshrrev_b32 v8, 2, v0
  v_and_b32 v9, 3, v0
  v_lshlrev_b32 v10, 4, v9
  v_cmp_eq_u32 vcc, 3, v9
  v_mov_b32 v11, 40
  s_nop 0
  v_cndmask_b32 v11, v10, v11, vcc
  v_mul_u32_u24 v12, 2688, v8
  v_add_u32 v12, v12, v11
  v_mul_u32_u24 v13, 3584, v8
  v_add_u32 v13, v13, v10
  s_mov_b32 s14, 0x75634120
  s_mov_b32 s15, 0xfecdab89
  s_lshl_b32 s3, s76, 2
  s_lshr_b64 s[14:15], s[14:15], s3
  s_and_b32 s13, s14, 15
  s_mul_i32 s3, s13, 56
  v_add_u32 v4, s3, v12
  s_mul_i32 s79, s76, 56
  v_add_u32 v5, s79, v12
  v_mov_b32 v6, v5
  s_lshl_b32 s3, s76, 6
  v_add_u32 v7, s3, v13
  v_mov_b32 v72, v7
  s_mul_i32 s64, s74, 43008
  s_add_u32 s65, s64, 896
  s_add_u32 s66, s64, 1792
  s_mul_i32 s67, s74, 57344
  s_mov_b32 s68, s67
  s_lshl_b32 s3, s74, 10
  s_add_u32 s69, s3, 32768
  s_add_u32 s70, s3, 36864
  s_add_u32 s71, s3, 40960
  s_add_u32 s72, s3, 45056
  s_add_u32 s73, s3, 49184
  v_lshlrev_b32 v8, 1, v1
  buffer_load_ushort v10, v8, s[52:55], 0 offen
  buffer_load_ushort v12, v8, s[52:55], 0 offen offset:512
  s_mul_i32 s3, s83, 172032
  s_add_u32 s64, s64, s3
  s_mul_i32 s3, s83, 172032
  s_add_u32 s65, s65, s3
  s_mul_i32 s3, s83, 172032
  s_add_u32 s66, s66, s3
  s_mul_i32 s3, s83, 229376
  s_add_u32 s67, s67, s3
  s_mul_i32 s3, s83, 229376
  s_add_u32 s68, s68, s3
  s_lshl_b32 s3, s83, 9
  v_mov_b32 v8, s3
  v_cndmask_b32 v8, 0, v8, s[22:23]
  v_add_u32 v79, v8, v79
  v_add_u32 v80, v8, v80
  s_cmp_lt_u32 s82, 4
  s_cbranch_scc1 K1A_COMPUTE
  s_mov_b32 s10, 0
  s_add_u32 s11, s78, s10
  s_add_u32 m0, s11, 0
  s_add_u32 s79, s94, 0
  buffer_load_dwordx4 v2, s[24:27], s79 offen lds
  s_add_u32 m0, s11, 1024
  s_add_u32 s79, s94, 7168
  buffer_load_dwordx4 v3, s[24:27], s79 offen lds
  s_add_u32 m0, s11, 2048
  s_add_u32 s79, s94, 14336
  buffer_load_dwordx4 v2, s[24:27], s79 offen lds
  s_add_u32 m0, s11, 3072
  s_add_u32 s79, s94, 21504
  buffer_load_dwordx4 v3, s[24:27], s79 offen lds
  s_add_u32 m0, s11, 4096
  s_add_u32 s79, s94, 28672
  buffer_load_dwordx4 v2, s[24:27], s79 offen lds
  s_add_u32 m0, s11, 5120
  s_add_u32 s79, s94, 35840
  buffer_load_dwordx4 v3, s[24:27], s79 offen lds
  s_add_u32 m0, s11, 6144
  s_add_u32 s79, s94, 43008
  buffer_load_dwordx4 v2, s[24:27], s79 offen lds
  s_add_u32 m0, s11, 7168
  s_add_u32 s79, s94, 50176
  buffer_load_dwordx4 v3, s[24:27], s79 offen lds
  s_add_u32 s94, s94, 128
  s_add_u32 m0, s69, s10
  s_nop 0
  buffer_load_dwordx4 v4, s[28:31], s64 offen lds
  s_add_u32 s64, s64, 172032
  s_add_u32 m0, s70, s10
  s_nop 0
  buffer_load_dwordx4 v5, s[28:31], s65 offen lds
  s_add_u32 s65, s65, 172032
  s_add_u32 m0, s71, s10
  s_nop 0
  buffer_load_dwordx4 v6, s[28:31], s66 offen lds
  s_add_u32 s66, s66, 172032
  s_add_u32 m0, s72, s10
  s_nop 0
  buffer_load_dwordx4 v7, s[32:35], s67 offen lds
  s_add_u32 s67, s67, 229376
  s_add_u32 m0, s73, s10
  s_nop 0
  buffer_load_dwordx4 v72, s[36:39], s68 offen lds
  s_add_u32 s68, s68, 229376
  s_add_u32 s10, s10, 53376
  s_cmp_eq_u32 s10, 160128
  s_cselect_b32 s10, 0, s10
  s_waitcnt vmcnt(13)
  v_lshl_or_b32 v10, v10, 16, v10
  v_mov_b32 v11, v10
  v_lshl_or_b32 v12, v12, 16, v12
  v_mov_b32 v13, v12
  v_lshlrev_b32 v8, 3, v1
  v_add_u32 v8, 160128, v8
  ds_write_b64 v8, v[10:11]
  v_cmp_gt_u32 vcc, 192, v1
  s_nop 0
  s_and_saveexec_b64 s[92:93], vcc
  ds_write_b64 v8, v[12:13] offset:2048
  s_mov_b64 exec, s[92:93]
  s_add_u32 s11, s78, s10
  s_add_u32 m0, s11, 0
  s_add_u32 s79, s94, 0
  buffer_load_dwordx4 v2, s[24:27], s79 offen lds
  s_add_u32 m0, s11, 1024
  s_add_u32 s79, s94, 7168
  buffer_load_dwordx4 v3, s[24:27], s79 offen lds
  s_add_u32 m0, s11, 2048
  s_add_u32 s79, s94, 14336
  buffer_load_dwordx4 v2, s[24:27], s79 offen lds
  s_add_u32 m0, s11, 3072
  s_add_u32 s79, s94, 21504
  buffer_load_dwordx4 v3, s[24:27], s79 offen lds
  s_add_u32 m0, s11, 4096
  s_add_u32 s79, s94, 28672
  buffer_load_dwordx4 v2, s[24:27], s79 offen lds
  s_add_u32 m0, s11, 5120
  s_add_u32 s79, s94, 35840
  buffer_load_dwordx4 v3, s[24:27], s79 offen lds
  s_add_u32 m0, s11, 6144
  s_add_u32 s79, s94, 43008
  buffer_load_dwordx4 v2, s[24:27], s79 offen lds
  s_add_u32 m0, s11, 7168
  s_add_u32 s79, s94, 50176
  buffer_load_dwordx4 v3, s[24:27], s79 offen lds
  s_add_u32 s94, s94, 128
  s_add_u32 m0, s69, s10
  s_nop 0
  buffer_load_dwordx4 v4, s[28:31], s64 offen lds
  s_add_u32 s64, s64, 172032
  s_add_u32 m0, s70, s10
  s_nop 0
  buffer_load_dwordx4 v5, s[28:31], s65 offen lds
  s_add_u32 s65, s65, 172032
  s_add_u32 m0, s71, s10
  s_nop 0
  buffer_load_dwordx4 v6, s[28:31], s66 offen lds
  s_add_u32 s66, s66, 172032
  s_add_u32 m0, s72, s10
  s_nop 0
  buffer_load_dwordx4 v7, s[32:35], s67 offen lds
  s_add_u32 s67, s67, 229376
  s_add_u32 m0, s73, s10
  s_nop 0
  buffer_load_dwordx4 v72, s[36:39], s68 offen lds
  s_add_u32 s68, s68, 229376
  s_add_u32 s10, s10, 53376
  s_cmp_eq_u32 s10, 160128
  s_cselect_b32 s10, 0, s10
  s_waitcnt vmcnt(13) lgkmcnt(0)
  s_barrier
  s_add_u32 s11, s78, s10
  s_add_u32 m0, s11, 0
  s_add_u32 s79, s94, 0
  buffer_load_dwordx4 v2, s[24:27], s79 offen lds
  s_add_u32 m0, s11, 1024
  s_add_u32 s79, s94, 7168
  buffer_load_dwordx4 v3, s[24:27], s79 offen lds
  s_add_u32 m0, s11, 2048
  s_add_u32 s79, s94, 14336
  buffer_load_dwordx4 v2, s[24:27], s79 offen lds
  s_add_u32 m0, s11, 3072
  s_add_u32 s79, s94, 21504
  buffer_load_dwordx4 v3, s[24:27], s79 offen lds
  s_add_u32 m0, s11, 4096
  s_add_u32 s79, s94, 28672
  buffer_load_dwordx4 v2, s[24:27], s79 offen lds
  s_add_u32 m0, s11, 5120
  s_add_u32 s79, s94, 35840
  buffer_load_dwordx4 v3, s[24:27], s79 offen lds
  s_add_u32 m0, s11, 6144
  s_add_u32 s79, s94, 43008
  buffer_load_dwordx4 v2, s[24:27], s79 offen lds
  s_add_u32 m0, s11, 7168
  s_add_u32 s79, s94, 50176
  buffer_load_dwordx4 v3, s[24:27], s79 offen lds
  s_add_u32 s94, s94, 128
  s_add_u32 m0, s69, s10
  s_nop 0
  buffer_load_dwordx4 v4, s[28:31], s64 offen lds
  s_add_u32 s64, s64, 172032
  s_add_u32 m0, s70, s10
  s_nop 0
  buffer_load_dwordx4 v5, s[28:31], s65 offen lds
  s_add_u32 s65, s65, 172032
  s_add_u32 m0, s71, s10
  s_nop 0
  buffer_load_dwordx4 v6, s[28:31], s66 offen lds
  s_add_u32 s66, s66, 172032
  s_add_u32 m0, s72, s10
  s_nop 0
  buffer_load_dwordx4 v7, s[32:35], s67 offen lds
  s_add_u32 s67, s67, 229376
  s_add_u32 m0, s73, s10
  s_nop 0
  buffer_load_dwordx4 v72, s[36:39], s68 offen lds
  s_add_u32 s68, s68, 229376
  s_add_u32 s10, s10, 53376
  s_cmp_eq_u32 s10, 160128
  s_cselect_b32 s10, 0, s10
  s_mov_b32 s12, 0
K1A_LLOOP:
  s_waitcnt vmcnt(13)
  s_barrier
  s_add_u32 s11, s78, s10
  s_add_u32 m0, s11, 0
  s_add_u32 s79, s94, 0
  buffer_load_dwordx4 v2, s[24:27], s79 offen lds
  s_add_u32 m0, s11, 1024
  s_add_u32 s79, s94, 7168
  buffer_load_dwordx4 v3, s[24:27], s79 offen lds
  s_add_u32 m0, s11, 2048
  s_add_u32 s79, s94, 14336
  buffer_load_dwordx4 v2, s[24:27], s79 offen lds
  s_add_u32 m0, s11, 3072
  s_add_u32 s79, s94, 21504
  buffer_load_dwordx4 v3, s[24:27], s79 offen lds
  s_add_u32 m0, s11, 4096
  s_add_u32 s79, s94, 28672
  buffer_load_dwordx4 v2, s[24:27], s79 offen lds
  s_add_u32 m0, s11, 5120
  s_add_u32 s79, s94, 35840
  buffer_load_dwordx4 v3, s[24:27], s79 offen lds
  s_add_u32 m0, s11, 6144
  s_add_u32 s79, s94, 43008
  buffer_load_dwordx4 v2, s[24:27], s79 offen lds
  s_add_u32 m0, s11, 7168
  s_add_u32 s79, s94, 50176
  buffer_load_dwordx4 v3, s[24:27], s79 offen lds
  s_add_u32 s94, s94, 128
  s_add_u32 m0, s69, s10
  s_nop 0
  buffer_load_dwordx4 v4, s[28:31], s64 offen lds
  s_add_u32 s64, s64, 172032
  s_add_u32 m0, s70, s10
  s_nop 0
  buffer_load_dwordx4 v5, s[28:31], s65 offen lds
  s_add_u32 s65, s65, 172032
  s_add_u32 m0, s71, s10
  s_nop 0
  buffer_load_dwordx4 v6, s[28:31], s66 offen lds
  s_add_u32 s66, s66, 172032
  s_add_u32 m0, s72, s10
  s_nop 0
  buffer_load_dwordx4 v7, s[32:35], s67 offen lds
  s_add_u32 s67, s67, 229376
  s_add_u32 m0, s73, s10
  s_nop 0
  buffer_load_dwordx4 v72, s[36:39], s68 offen lds
  s_add_u32 s68, s68, 229376
  s_add_u32 s10, s10, 53376
  s_cmp_eq_u32 s10, 160128
  s_cselect_b32 s10, 0, s10
  s_add_u32 s12, s12, 1
  s_cmp_lt_u32 s12, 4
  s_cbranch_scc1 K1A_LLOOP
  s_waitcnt vmcnt(13)
  s_barrier
  s_waitcnt vmcnt(0)
  s_barrier
  s_barrier
  s_cmp_lg_u32 s74, 0
  s_cbranch_scc1 K1A_DONE
  v_add_u32 v8, 53376, v83
  ds_read_b128 v[96:99], v8 offset:0
  ds_read_b128 v[100:103], v8 offset:1024
  ds_read_b128 v[104:107], v8 offset:2048
  ds_read_b128 v[108:111], v8 offset:3072
  ds_read_b128 v[112:115], v8 offset:4096
  ds_read_b128 v[116:119], v8 offset:5120
  ds_read_b128 v[120:123], v8 offset:6144
  ds_read_b128 v[124:127], v8 offset:7168
  ds_read_b128 v[128:131], v8 offset:8192
  ds_read_b128 v[132:135], v8 offset:9216
  ds_read_b128 v[136:139], v8 offset:10240
  ds_read_b128 v[140:143], v8 offset:11264
  ds_read_b128 v[144:147], v8 offset:12288
  ds_read_b128 v[148:151], v8 offset:13312
  ds_read_b128 v[152:155], v8 offset:14336
  ds_read_b128 v[156:159], v8 offset:15360
  s_lshl_b32 s3, s76, 3
  s_add_u32 s3, s3, s75
  s_lshl_b32 s3, s3, 12
  s_add_u32 s3, s3, 9437184
  s_waitcnt lgkmcnt(0)
  v_pk_add_f32 v[96:97], v[96:97], v[112:113]
  v_pk_add_f32 v[128:129], v[128:129], v[144:145]
  v_pk_add_f32 v[98:99], v[98:99], v[114:115]
  v_pk_add_f32 v[130:131], v[130:131], v[146:147]
  v_pk_add_f32 v[100:101], v[100:101], v[116:117]
  v_pk_add_f32 v[132:133], v[132:133], v[148:149]
  v_pk_add_f32 v[102:103], v[102:103], v[118:119]
  v_pk_add_f32 v[134:135], v[134:135], v[150:151]
  v_pk_add_f32 v[104:105], v[104:105], v[120:121]
  v_pk_add_f32 v[136:137], v[136:137], v[152:153]
  v_pk_add_f32 v[106:107], v[106:107], v[122:123]
  v_pk_add_f32 v[138:139], v[138:139], v[154:155]
  v_pk_add_f32 v[108:109], v[108:109], v[124:125]
  v_pk_add_f32 v[140:141], v[140:141], v[156:157]
  v_pk_add_f32 v[110:111], v[110:111], v[126:127]
  v_pk_add_f32 v[142:143], v[142:143], v[158:159]
  v_pk_add_f32 v[96:97], v[96:97], v[128:129]
  v_pk_add_f32 v[98:99], v[98:99], v[130:131]
  v_pk_add_f32 v[100:101], v[100:101], v[132:133]
  v_pk_add_f32 v[102:103], v[102:103], v[134:135]
  v_pk_add_f32 v[104:105], v[104:105], v[136:137]
  v_pk_add_f32 v[106:107], v[106:107], v[138:139]
  v_pk_add_f32 v[108:109], v[108:109], v[140:141]
  v_pk_add_f32 v[110:111], v[110:111], v[142:143]
  buffer_store_dwordx4 v[96:99], v83, s[40:43], s3 offen offset:0 sc1
  buffer_store_dwordx4 v[100:103], v83, s[40:43], s3 offen offset:1024 sc1
  buffer_store_dwordx4 v[104:107], v83, s[40:43], s3 offen offset:2048 sc1
  buffer_store_dwordx4 v[108:111], v83, s[40:43], s3 offen offset:3072 sc1
K1A_DONE:
  s_endpgm
K1A_COMPUTE:
  s_barrier
  ds_read_b128 v[56:59], v73
  ds_read_b128 v[60:63], v73 offset:4096
  ds_read_b64_tr_b16 v[16:17], v79
  ds_read_b64_tr_b16 v[18:19], v80
  ds_read_b64_tr_b16 v[20:21], v77 offset:4096
  ds_read_b64_tr_b16 v[22:23], v77 offset:4352
  ds_read_b64_tr_b16 v[24:25], v77 offset:8192
  ds_read_b64_tr_b16 v[26:27], v77 offset:8448
  ds_read_b64_tr_b16 v[28:29], v78 offset:0
  ds_read_b64_tr_b16 v[30:31], v78 offset:256
  ds_read_b64_tr_b16 v[32:33], v78 offset:32
  ds_read_b64_tr_b16 v[34:35], v78 offset:288
  s_mov_b32 s4, 0
  s_mov_b32 s5, 0
  s_waitcnt lgkmcnt(0)
  v_mfma_f32_32x32x16_bf16 v[96:111], v[16:19], v[56:59], 0
  v_add_u32 v79, v81, v79
  v_add_u32 v80, v81, v80
  ds_read_b128 v[64:67], v74
  ds_read_b128 v[68:71], v74 offset:4096
  v_mfma_f32_32x32x16_bf16 v[112:127], v[16:19], v[60:63], 0
  ds_read_b64_tr_b16 v[36:37], v79
  ds_read_b64_tr_b16 v[38:39], v80
  v_mfma_f32_32x32x16_bf16 v[128:143], v[56:59], v[20:23], 0
  ds_read_b64_tr_b16 v[40:41], v77 offset:5120
  ds_read_b64_tr_b16 v[42:43], v77 offset:5376
  v_mfma_f32_32x32x16_bf16 v[144:159], v[60:63], v[20:23], 0
  ds_read_b64_tr_b16 v[44:45], v77 offset:9216
  ds_read_b64_tr_b16 v[46:47], v77 offset:9472
  v_mfma_f32_32x32x16_bf16 v[160:175], v[56:59], v[24:27], 0
  ds_read_b64_tr_b16 v[48:49], v78 offset:1024
  ds_read_b64_tr_b16 v[50:51], v78 offset:1280
  v_mfma_f32_32x32x16_bf16 v[176:191], v[60:63], v[24:27], 0
  ds_read_b64_tr_b16 v[52:53], v78 offset:1056
  ds_read_b64_tr_b16 v[54:55], v78 offset:1312
  v_mfma_f32_32x32x16_bf16 v[192:207], v[28:31], v[56:59], 0
  v_mfma_f32_32x32x16_bf16 v[208:223], v[28:31], v[60:63], 0
  v_mfma_f32_32x32x16_bf16 v[224:239], v[32:35], v[56:59], 0
  v_mfma_f32_32x32x16_bf16 v[240:255], v[32:35], v[60:63], 0
K1A_LOOP:
  s_waitcnt lgkmcnt(0)
  v_mfma_f32_32x32x16_bf16 v[96:111], v[36:39], v[64:67], v[96:111]
  v_add_u32 v79, v81, v79
  v_add_u32 v80, v81, v80
  ds_read_b128 v[56:59], v75
  ds_read_b128 v[60:63], v75 offset:4096
  v_mfma_f32_32x32x16_bf16 v[112:127], v[36:39], v[68:71], v[112:127]
  ds_read_b64_tr_b16 v[16:17], v79
  ds_read_b64_tr_b16 v[18:19], v80
  v_mfma_f32_32x32x16_bf16 v[128:143], v[64:67], v[40:43], v[128:143]
  ds_read_b64_tr_b16 v[20:21], v77 offset:6144
  ds_read_b64_tr_b16 v[22:23], v77 offset:6400
  v_mfma_f32_32x32x16_bf16 v[144:159], v[68:71], v[40:43], v[144:159]
  ds_read_b64_tr_b16 v[24:25], v77 offset:10240
  ds_read_b64_tr_b16 v[26:27], v77 offset:10496
  v_mfma_f32_32x32x16_bf16 v[160:175], v[64:67], v[44:47], v[160:175]
  ds_read_b64_tr_b16 v[28:29], v78 offset:2048
  ds_read_b64_tr_b16 v[30:31], v78 offset:2304
  v_mfma_f32_32x32x16_bf16 v[176:191], v[68:71], v[44:47], v[176:191]
  ds_read_b64_tr_b16 v[32:33], v78 offset:2080
  ds_read_b64_tr_b16 v[34:35], v78 offset:2336
  v_mfma_f32_32x32x16_bf16 v[192:207], v[48:51], v[64:67], v[192:207]
  v_mfma_f32_32x32x16_bf16 v[208:223], v[48:51], v[68:71], v[208:223]
  v_mfma_f32_32x32x16_bf16 v[224:239], v[52:55], v[64:67], v[224:239]
  v_mfma_f32_32x32x16_bf16 v[240:255], v[52:55], v[68:71], v[240:255]
  s_waitcnt lgkmcnt(0)
  v_mfma_f32_32x32x16_bf16 v[96:111], v[16:19], v[56:59], v[96:111]
  v_add_u32 v79, v81, v79
  v_add_u32 v80, v81, v80
  ds_read_b128 v[64:67], v76
  ds_read_b128 v[68:71], v76 offset:4096
  v_mfma_f32_32x32x16_bf16 v[112:127], v[16:19], v[60:63], v[112:127]
  ds_read_b64_tr_b16 v[36:37], v79
  ds_read_b64_tr_b16 v[38:39], v80
  v_mfma_f32_32x32x16_bf16 v[128:143], v[56:59], v[20:23], v[128:143]
  ds_read_b64_tr_b16 v[40:41], v77 offset:7168
  ds_read_b64_tr_b16 v[42:43], v77 offset:7424
  v_mfma_f32_32x32x16_bf16 v[144:159], v[60:63], v[20:23], v[144:159]
  ds_read_b64_tr_b16 v[44:45], v77 offset:11264
  ds_read_b64_tr_b16 v[46:47], v77 offset:11520
  v_mfma_f32_32x32x16_bf16 v[160:175], v[56:59], v[24:27], v[160:175]
  ds_read_b64_tr_b16 v[48:49], v78 offset:3072
  ds_read_b64_tr_b16 v[50:51], v78 offset:3328
  v_mfma_f32_32x32x16_bf16 v[176:191], v[60:63], v[24:27], v[176:191]
  ds_read_b64_tr_b16 v[52:53], v78 offset:3104
  ds_read_b64_tr_b16 v[54:55], v78 offset:3360
  v_mfma_f32_32x32x16_bf16 v[192:207], v[28:31], v[56:59], v[192:207]
  v_mfma_f32_32x32x16_bf16 v[208:223], v[28:31], v[60:63], v[208:223]
  v_mfma_f32_32x32x16_bf16 v[224:239], v[32:35], v[56:59], v[224:239]
  v_mfma_f32_32x32x16_bf16 v[240:255], v[32:35], v[60:63], v[240:255]
  s_waitcnt lgkmcnt(0)
  s_cmp_eq_u32 s4, 6
  s_cbranch_scc1 K1A_NOBAR
  s_barrier
K1A_NOBAR:
  v_mfma_f32_32x32x16_bf16 v[96:111], v[36:39], v[64:67], v[96:111]
  s_add_u32 s5, s5, 1
  s_cmp_eq_u32 s5, 3
  s_cselect_b32 s5, 0, s5
  s_mov_b32 s6, 53376
  s_cselect_b32 s6, 0xfffe5f00, s6
  v_add_u32 v73, s6, v73
  v_add_u32 v74, s6, v74
  v_add_u32 v75, s6, v75
  v_add_u32 v76, s6, v76
  v_add_u32 v78, s6, v78
  v_add_u32 v77, s6, v77
  s_sub_u32 s3, s6, 3072
  v_mov_b32 v8, s3
  v_cndmask_b32 v8, v8, v82, s[22:23]
  v_add_u32 v79, v8, v79
  v_add_u32 v80, v8, v80
  ds_read_b128 v[56:59], v73
  ds_read_b128 v[60:63], v73 offset:4096
  v_mfma_f32_32x32x16_bf16 v[112:127], v[36:39], v[68:71], v[112:127]
  ds_read_b64_tr_b16 v[16:17], v79
  ds_read_b64_tr_b16 v[18:19], v80
  v_mfma_f32_32x32x16_bf16 v[128:143], v[64:67], v[40:43], v[128:143]
  ds_read_b64_tr_b16 v[20:21], v77 offset:4096
  ds_read_b64_tr_b16 v[22:23], v77 offset:4352
  v_mfma_f32_32x32x16_bf16 v[144:159], v[68:71], v[40:43], v[144:159]
  ds_read_b64_tr_b16 v[24:25], v77 offset:8192
  ds_read_b64_tr_b16 v[26:27], v77 offset:8448
  v_mfma_f32_32x32x16_bf16 v[160:175], v[64:67], v[44:47], v[160:175]
  ds_read_b64_tr_b16 v[28:29], v78 offset:0
  ds_read_b64_tr_b16 v[30:31], v78 offset:256
  v_mfma_f32_32x32x16_bf16 v[176:191], v[68:71], v[44:47], v[176:191]
  ds_read_b64_tr_b16 v[32:33], v78 offset:32
  ds_read_b64_tr_b16 v[34:35], v78 offset:288
  v_mfma_f32_32x32x16_bf16 v[192:207], v[48:51], v[64:67], v[192:207]
  v_mfma_f32_32x32x16_bf16 v[208:223], v[48:51], v[68:71], v[208:223]
  v_mfma_f32_32x32x16_bf16 v[224:239], v[52:55], v[64:67], v[224:239]
  v_mfma_f32_32x32x16_bf16 v[240:255], v[52:55], v[68:71], v[240:255]
  s_cmp_eq_u32 s4, 6
  s_cbranch_scc1 K1A_LOOPEND
  s_waitcnt lgkmcnt(0)
  v_mfma_f32_32x32x16_bf16 v[96:111], v[16:19], v[56:59], v[96:111]
  v_add_u32 v79, v81, v79
  v_add_u32 v80, v81, v80
  ds_read_b128 v[64:67], v74
  ds_read_b128 v[68:71], v74 offset:4096
  v_mfma_f32_32x32x16_bf16 v[112:127], v[16:19], v[60:63], v[112:127]
  ds_read_b64_tr_b16 v[36:37], v79
  ds_read_b64_tr_b16 v[38:39], v80
  v_mfma_f32_32x32x16_bf16 v[128:143], v[56:59], v[20:23], v[128:143]
  ds_read_b64_tr_b16 v[40:41], v77 offset:5120
  ds_read_b64_tr_b16 v[42:43], v77 offset:5376
  v_mfma_f32_32x32x16_bf16 v[144:159], v[60:63], v[20:23], v[144:159]
  ds_read_b64_tr_b16 v[44:45], v77 offset:9216
  ds_read_b64_tr_b16 v[46:47], v77 offset:9472
  v_mfma_f32_32x32x16_bf16 v[160:175], v[56:59], v[24:27], v[160:175]
  ds_read_b64_tr_b16 v[48:49], v78 offset:1024
  ds_read_b64_tr_b16 v[50:51], v78 offset:1280
  v_mfma_f32_32x32x16_bf16 v[176:191], v[60:63], v[24:27], v[176:191]
  ds_read_b64_tr_b16 v[52:53], v78 offset:1056
  ds_read_b64_tr_b16 v[54:55], v78 offset:1312
  v_mfma_f32_32x32x16_bf16 v[192:207], v[28:31], v[56:59], v[192:207]
  v_mfma_f32_32x32x16_bf16 v[208:223], v[28:31], v[60:63], v[208:223]
  v_mfma_f32_32x32x16_bf16 v[224:239], v[32:35], v[56:59], v[224:239]
  v_mfma_f32_32x32x16_bf16 v[240:255], v[32:35], v[60:63], v[240:255]
  s_add_u32 s4, s4, 1
  s_branch K1A_LOOP
K1A_LOOPEND:
  s_waitcnt lgkmcnt(0)
  s_nop 7
  s_nop 7
  s_lshl_b32 s81, s75, 3
  s_lshl_b32 s3, s74, 1
  s_add_u32 s81, s81, s3
  v_and_b32 v8, 31, v0
  v_cmp_le_u32 s[22:23], 28, v8
  v_mov_b32 v9, 0x3f803f80
  v_pk_mul_f32 v[16:17], v[128:129], s[84:85]
  v_pk_mul_f32 v[18:19], v[130:131], s[84:85]
  v_pk_mul_f32 v[20:21], v[132:133], s[84:85]
  v_pk_mul_f32 v[22:23], v[134:135], s[84:85]
  v_pk_mul_f32 v[24:25], v[136:137], s[84:85]
  v_pk_mul_f32 v[26:27], v[138:139], s[84:85]
  v_pk_mul_f32 v[28:29], v[140:141], s[84:85]
  v_pk_mul_f32 v[30:31], v[142:143], s[84:85]
  v_exp_f32 v16, v16 clamp
  v_exp_f32 v17, v17 clamp
  v_exp_f32 v18, v18 clamp
  v_exp_f32 v19, v19 clamp
  v_exp_f32 v20, v20 clamp
  v_exp_f32 v21, v21 clamp
  v_exp_f32 v22, v22 clamp
  v_exp_f32 v23, v23 clamp
  v_exp_f32 v24, v24 clamp
  v_exp_f32 v25, v25 clamp
  v_exp_f32 v26, v26 clamp
  v_exp_f32 v27, v27 clamp
  v_exp_f32 v28, v28 clamp
  v_exp_f32 v29, v29 clamp
  v_exp_f32 v30, v30 clamp
  v_exp_f32 v31, v31 clamp
  v_max_f32 v128, 0, v128
  v_max_f32 v129, 0, v129
  v_max_f32 v130, 0, v130
  v_max_f32 v131, 0, v131
  v_max_f32 v132, 0, v132
  v_max_f32 v133, 0, v133
  v_max_f32 v134, 0, v134
  v_max_f32 v135, 0, v135
  v_max_f32 v136, 0, v136
  v_max_f32 v137, 0, v137
  v_max_f32 v138, 0, v138
  v_max_f32 v139, 0, v139
  v_max_f32 v140, 0, v140
  v_max_f32 v141, 0, v141
  v_max_f32 v142, 0, v142
  v_max_f32 v143, 0, v143
  v_pk_add_f32 v[128:129], v[128:129], s[86:87]
  v_pk_add_f32 v[130:131], v[130:131], s[86:87]
  v_pk_add_f32 v[132:133], v[132:133], s[86:87]
  v_pk_add_f32 v[134:135], v[134:135], s[86:87]
  v_pk_add_f32 v[136:137], v[136:137], s[86:87]
  v_pk_add_f32 v[138:139], v[138:139], s[86:87]
  v_pk_add_f32 v[140:141], v[140:141], s[86:87]
  v_pk_add_f32 v[142:143], v[142:143], s[86:87]
  v_pk_add_f32 v[128:129], v[128:129], v[16:17]
  v_pk_add_f32 v[130:131], v[130:131], v[18:19]
  v_pk_add_f32 v[132:133], v[132:133], v[20:21]
  v_pk_add_f32 v[134:135], v[134:135], v[22:23]
  v_pk_add_f32 v[136:137], v[136:137], v[24:25]
  v_pk_add_f32 v[138:139], v[138:139], v[26:27]
  v_pk_add_f32 v[140:141], v[140:141], v[28:29]
  v_pk_add_f32 v[142:143], v[142:143], v[30:31]
  v_cvt_pk_bf16_f32 v36, v128, v129
  v_cvt_pk_bf16_f32 v37, v130, v131
  v_cvt_pk_bf16_f32 v38, v132, v133
  v_cvt_pk_bf16_f32 v39, v134, v135
  v_cvt_pk_bf16_f32 v40, v136, v137
  v_cvt_pk_bf16_f32 v41, v138, v139
  v_cvt_pk_bf16_f32 v42, v140, v141
  v_cvt_pk_bf16_f32 v43, v142, v143
  v_cvt_pk_bf16_f32 v44, v160, v161
  v_cvt_pk_bf16_f32 v45, v162, v163
  v_cvt_pk_bf16_f32 v46, v164, v165
  v_cvt_pk_bf16_f32 v47, v166, v167
  v_cvt_pk_bf16_f32 v48, v168, v169
  v_cvt_pk_bf16_f32 v49, v170, v171
  v_cvt_pk_bf16_f32 v50, v172, v173
  v_cvt_pk_bf16_f32 v51, v174, v175
  v_cndmask_b32 v44, v44, v9, s[22:23]
  v_cndmask_b32 v45, v45, v9, s[22:23]
  v_cndmask_b32 v46, v46, v9, s[22:23]
  v_cndmask_b32 v47, v47, v9, s[22:23]
  v_cndmask_b32 v48, v48, v9, s[22:23]
  v_cndmask_b32 v49, v49, v9, s[22:23]
  v_cndmask_b32 v50, v50, v9, s[22:23]
  v_cndmask_b32 v51, v51, v9, s[22:23]
  v_mfma_f32_32x32x16_bf16 v[56:71], v[36:39], v[44:47], 0
  s_nop 0
  v_mfma_f32_32x32x16_bf16 v[56:71], v[40:43], v[48:51], v[56:71]
  v_pk_mul_f32 v[16:17], v[144:145], s[84:85]
  v_pk_mul_f32 v[18:19], v[146:147], s[84:85]
  v_pk_mul_f32 v[20:21], v[148:149], s[84:85]
  v_pk_mul_f32 v[22:23], v[150:151], s[84:85]
  v_pk_mul_f32 v[24:25], v[152:153], s[84:85]
  v_pk_mul_f32 v[26:27], v[154:155], s[84:85]
  v_pk_mul_f32 v[28:29], v[156:157], s[84:85]
  v_pk_mul_f32 v[30:31], v[158:159], s[84:85]
  v_exp_f32 v16, v16 clamp
  v_exp_f32 v17, v17 clamp
  v_exp_f32 v18, v18 clamp
  v_exp_f32 v19, v19 clamp
  v_exp_f32 v20, v20 clamp
  v_exp_f32 v21, v21 clamp
  v_exp_f32 v22, v22 clamp
  v_exp_f32 v23, v23 clamp
  v_exp_f32 v24, v24 clamp
  v_exp_f32 v25, v25 clamp
  v_exp_f32 v26, v26 clamp
  v_exp_f32 v27, v27 clamp
  v_exp_f32 v28, v28 clamp
  v_exp_f32 v29, v29 clamp
  v_exp_f32 v30, v30 clamp
  v_exp_f32 v31, v31 clamp
  v_max_f32 v144, 0, v144
  v_max_f32 v145, 0, v145
  v_max_f32 v146, 0, v146
  v_max_f32 v147, 0, v147
  v_max_f32 v148, 0, v148
  v_max_f32 v149, 0, v149
  v_max_f32 v150, 0, v150
  v_max_f32 v151, 0, v151
  v_max_f32 v152, 0, v152
  v_max_f32 v153, 0, v153
  v_max_f32 v154, 0, v154
  v_max_f32 v155, 0, v155
  v_max_f32 v156, 0, v156
  v_max_f32 v157, 0, v157
  v_max_f32 v158, 0, v158
  v_max_f32 v159, 0, v159
  v_pk_add_f32 v[144:145], v[144:145], s[86:87]
  v_pk_add_f32 v[146:147], v[146:147], s[86:87]
  v_pk_add_f32 v[148:149], v[148:149], s[86:87]
  v_pk_add_f32 v[150:151], v[150:151], s[86:87]
  v_pk_add_f32 v[152:153], v[152:153], s[86:87]
  v_pk_add_f32 v[154:155], v[154:155], s[86:87]
  v_pk_add_f32 v[156:157], v[156:157], s[86:87]
  v_pk_add_f32 v[158:159], v[158:159], s[86:87]
  v_pk_add_f32 v[144:145], v[144:145], v[16:17]
  v_pk_add_f32 v[146:147], v[146:147], v[18:19]
  v_pk_add_f32 v[148:149], v[148:149], v[20:21]
  v_pk_add_f32 v[150:151], v[150:151], v[22:23]
  v_pk_add_f32 v[152:153], v[152:153], v[24:25]
  v_pk_add_f32 v[154:155], v[154:155], v[26:27]
  v_pk_add_f32 v[156:157], v[156:157], v[28:29]
  v_pk_add_f32 v[158:159], v[158:159], v[30:31]
  v_cvt_pk_bf16_f32 v36, v144, v145
  v_cvt_pk_bf16_f32 v37, v146, v147
  v_cvt_pk_bf16_f32 v38, v148, v149
  v_cvt_pk_bf16_f32 v39, v150, v151
  v_cvt_pk_bf16_f32 v40, v152, v153
  v_cvt_pk_bf16_f32 v41, v154, v155
  v_cvt_pk_bf16_f32 v42, v156, v157
  v_cvt_pk_bf16_f32 v43, v158, v159
  v_cvt_pk_bf16_f32 v44, v176, v177
  v_cvt_pk_bf16_f32 v45, v178, v179
  v_cvt_pk_bf16_f32 v46, v180, v181
  v_cvt_pk_bf16_f32 v47, v182, v183
  v_cvt_pk_bf16_f32 v48, v184, v185
  v_cvt_pk_bf16_f32 v49, v186, v187
  v_cvt_pk_bf16_f32 v50, v188, v189
  v_cvt_pk_bf16_f32 v51, v190, v191
  v_cndmask_b32 v44, v44, v9, s[22:23]
  v_cndmask_b32 v45, v45, v9, s[22:23]
  v_cndmask_b32 v46, v46, v9, s[22:23]
  v_cndmask_b32 v47, v47, v9, s[22:23]
  v_cndmask_b32 v48, v48, v9, s[22:23]
  v_cndmask_b32 v49, v49, v9, s[22:23]
  v_cndmask_b32 v50, v50, v9, s[22:23]
  v_cndmask_b32 v51, v51, v9, s[22:23]
  v_mfma_f32_32x32x16_bf16 v[56:71], v[36:39], v[44:47], v[56:71]
  s_nop 0
  v_mfma_f32_32x32x16_bf16 v[56:71], v[40:43], v[48:51], v[56:71]
  s_lshl_b32 s3, s74, 12
  v_add_u32 v8, s3, v83
  v_add_u32 v8, 53376, v8
  s_nop 8
  ds_write_b128 v8, v[56:59] offset:0
  ds_write_b128 v8, v[60:63] offset:1024
  ds_write_b128 v8, v[64:67] offset:2048
  ds_write_b128 v8, v[68:71] offset:3072
  s_waitcnt lgkmcnt(0)
  s_barrier
  v_mov_b32 v10, v108
  v_mov_b32 v11, v124
  s_lshl_b32 s3, s81, 4
  s_add_u32 s3, s3, s13
  s_lshl_b32 s3, s3, 11
  s_add_u32 s79, s3, 32768
  v_pk_mul_f32 v[16:17], v[96:97], s[84:85]
  v_pk_mul_f32 v[18:19], v[98:99], s[84:85]
  v_pk_mul_f32 v[20:21], v[100:101], s[84:85]
  v_pk_mul_f32 v[22:23], v[102:103], s[84:85]
  v_pk_mul_f32 v[24:25], v[104:105], s[84:85]
  v_pk_mul_f32 v[26:27], v[106:107], s[84:85]
  v_pk_mul_f32 v[28:29], v[108:109], s[84:85]
  v_pk_mul_f32 v[30:31], v[110:111], s[84:85]
  v_exp_f32 v16, v16 clamp
  v_exp_f32 v17, v17 clamp
  v_exp_f32 v18, v18 clamp
  v_exp_f32 v19, v19 clamp
  v_exp_f32 v20, v20 clamp
  v_exp_f32 v21, v21 clamp
  v_exp_f32 v22, v22 clamp
  v_exp_f32 v23, v23 clamp
  v_exp_f32 v24, v24 clamp
  v_exp_f32 v25, v25 clamp
  v_exp_f32 v26, v26 clamp
  v_exp_f32 v27, v27 clamp
  v_exp_f32 v28, v28 clamp
  v_exp_f32 v29, v29 clamp
  v_exp_f32 v30, v30 clamp
  v_exp_f32 v31, v31 clamp
  v_max_f32 v96, 0, v96
  v_max_f32 v97, 0, v97
  v_max_f32 v98, 0, v98
  v_max_f32 v99, 0, v99
  v_max_f32 v100, 0, v100
  v_max_f32 v101, 0, v101
  v_max_f32 v102, 0, v102
  v_max_f32 v103, 0, v103
  v_max_f32 v104, 0, v104
  v_max_f32 v105, 0, v105
  v_max_f32 v106, 0, v106
  v_max_f32 v107, 0, v107
  v_max_f32 v108, 0, v108
  v_max_f32 v109, 0, v109
  v_max_f32 v110, 0, v110
  v_max_f32 v111, 0, v111
  v_pk_add_f32 v[96:97], v[96:97], s[86:87]
  v_pk_add_f32 v[98:99], v[98:99], s[86:87]
  v_pk_add_f32 v[100:101], v[100:101], s[86:87]
  v_pk_add_f32 v[102:103], v[102:103], s[86:87]
  v_pk_add_f32 v[104:105], v[104:105], s[86:87]
  v_pk_add_f32 v[106:107], v[106:107], s[86:87]
  v_pk_add_f32 v[108:109], v[108:109], s[86:87]
  v_pk_add_f32 v[110:111], v[110:111], s[86:87]
  v_pk_add_f32 v[96:97], v[96:97], v[16:17]
  v_pk_add_f32 v[98:99], v[98:99], v[18:19]
  v_pk_add_f32 v[100:101], v[100:101], v[20:21]
  v_pk_add_f32 v[102:103], v[102:103], v[22:23]
  v_pk_add_f32 v[104:105], v[104:105], v[24:25]
  v_pk_add_f32 v[106:107], v[106:107], v[26:27]
  v_pk_add_f32 v[108:109], v[108:109], v[28:29]
  v_pk_add_f32 v[110:111], v[110:111], v[30:31]
  v_cvt_pk_bf16_f32 v36, v96, v97
  v_cvt_pk_bf16_f32 v37, v98, v99
  v_cvt_pk_bf16_f32 v38, v100, v101
  v_cvt_pk_bf16_f32 v39, v102, v103
  v_cvt_pk_bf16_f32 v40, v104, v105
  v_cvt_pk_bf16_f32 v41, v106, v107
  v_cvt_pk_bf16_f32 v42, v108, v109
  v_cvt_pk_bf16_f32 v43, v110, v111
  buffer_store_dwordx4 v[36:39], v83, s[40:43], s3 offen sc1
  buffer_store_dwordx4 v[40:43], v83, s[40:43], s3 offen offset:1024 sc1
  v_pk_mul_f32 v[16:17], v[112:113], s[84:85]
  v_pk_mul_f32 v[18:19], v[114:115], s[84:85]
  v_pk_mul_f32 v[20:21], v[116:117], s[84:85]
  v_pk_mul_f32 v[22:23], v[118:119], s[84:85]
  v_pk_mul_f32 v[24:25], v[120:121], s[84:85]
  v_pk_mul_f32 v[26:27], v[122:123], s[84:85]
  v_pk_mul_f32 v[28:29], v[124:125], s[84:85]
  v_pk_mul_f32 v[30:31], v[126:127], s[84:85]
  v_exp_f32 v16, v16 clamp
  v_exp_f32 v17, v17 clamp
  v_exp_f32 v18, v18 clamp
  v_exp_f32 v19, v19 clamp
  v_exp_f32 v20, v20 clamp
  v_exp_f32 v21, v21 clamp
  v_exp_f32 v22, v22 clamp
  v_exp_f32 v23, v23 clamp
  v_exp_f32 v24, v24 clamp
  v_exp_f32 v25, v25 clamp
  v_exp_f32 v26, v26 clamp
  v_exp_f32 v27, v27 clamp
  v_exp_f32 v28, v28 clamp
  v_exp_f32 v29, v29 clamp
  v_exp_f32 v30, v30 clamp
  v_exp_f32 v31, v31 clamp
  v_max_f32 v112, 0, v112
  v_max_f32 v113, 0, v113
  v_max_f32 v114, 0, v114
  v_max_f32 v115, 0, v115
  v_max_f32 v116, 0, v116
  v_max_f32 v117, 0, v117
  v_max_f32 v118, 0, v118
  v_max_f32 v119, 0, v119
  v_max_f32 v120, 0, v120
  v_max_f32 v121, 0, v121
  v_max_f32 v122, 0, v122
  v_max_f32 v123, 0, v123
  v_max_f32 v124, 0, v124
  v_max_f32 v125, 0, v125
  v_max_f32 v126, 0, v126
  v_max_f32 v127, 0, v127
  v_pk_add_f32 v[112:113], v[112:113], s[86:87]
  v_pk_add_f32 v[114:115], v[114:115], s[86:87]
  v_pk_add_f32 v[116:117], v[116:117], s[86:87]
  v_pk_add_f32 v[118:119], v[118:119], s[86:87]
  v_pk_add_f32 v[120:121], v[120:121], s[86:87]
  v_pk_add_f32 v[122:123], v[122:123], s[86:87]
  v_pk_add_f32 v[124:125], v[124:125], s[86:87]
  v_pk_add_f32 v[126:127], v[126:127], s[86:87]
  v_pk_add_f32 v[112:113], v[112:113], v[16:17]
  v_pk_add_f32 v[114:115], v[114:115], v[18:19]
  v_pk_add_f32 v[116:117], v[116:117], v[20:21]
  v_pk_add_f32 v[118:119], v[118:119], v[22:23]
  v_pk_add_f32 v[120:121], v[120:121], v[24:25]
  v_pk_add_f32 v[122:123], v[122:123], v[26:27]
  v_pk_add_f32 v[124:125], v[124:125], v[28:29]
  v_pk_add_f32 v[126:127], v[126:127], v[30:31]
  v_cvt_pk_bf16_f32 v44, v112, v113
  v_cvt_pk_bf16_f32 v45, v114, v115
  v_cvt_pk_bf16_f32 v46, v116, v117
  v_cvt_pk_bf16_f32 v47, v118, v119
  v_cvt_pk_bf16_f32 v48, v120, v121
  v_cvt_pk_bf16_f32 v49, v122, v123
  v_cvt_pk_bf16_f32 v50, v124, v125
  v_cvt_pk_bf16_f32 v51, v126, v127
  buffer_store_dwordx4 v[44:47], v83, s[40:43], s79 offen sc1
  buffer_store_dwordx4 v[48:51], v83, s[40:43], s79 offen offset:1024 sc1
  s_cmp_lg_u32 s76, 0
  s_cbranch_scc1 K1A_NOG
  v_cvt_pk_bf16_f32 v12, v10, v11
  v_lshlrev_b32 v10, 16, v12
  v_and_b32 v11, 0xffff0000, v12
  v_pk_mul_f32 v[10:11], v[10:11], s[88:89]
  v_exp_f32 v10, v10
  v_exp_f32 v11, v11
  s_nop 0
  v_pk_add_f32 v[10:11], v[10:11], s[90:91]
  v_rcp_f32 v10, v10
  v_rcp_f32 v11, v11
  s_nop 0
  v_cvt_pk_bf16_f32 v12, v10, v11
  v_lshlrev_b32 v10, 16, v12
  v_and_b32 v11, 0xffff0000, v12
  v_and_b32 v12, 31, v0
  v_lshlrev_b32 v12, 2, v12
  s_lshl_b32 s3, s81, 7
  s_add_u32 s3, s3, 12058624
  v_cmp_le_u32 vcc, 32, v0
  s_nop 0
  s_and_saveexec_b64 s[92:93], vcc
  buffer_store_dword v10, v12, s[40:43], s3 offen
  buffer_store_dword v11, v12, s[40:43], s3 offen offset:128
  s_mov_b64 exec, s[92:93]
K1A_NOG:
  s_mul_i32 s3, s81, 112
  s_lshl_b32 s79, s76, 1
  s_add_u32 s3, s3, s79
  s_lshl_b32 s3, s3, 10
  s_add_u32 s3, s3, 2097152
  s_add_u32 s79, s3, 114688
  v_pk_mul_f32 v[16:17], v[192:193], s[88:89]
  v_pk_mul_f32 v[18:19], v[194:195], s[88:89]
  v_pk_mul_f32 v[20:21], v[196:197], s[88:89]
  v_pk_mul_f32 v[22:23], v[198:199], s[88:89]
  v_exp_f32 v16, v16
  v_exp_f32 v17, v17
  v_exp_f32 v18, v18
  v_exp_f32 v19, v19
  v_exp_f32 v20, v20
  v_exp_f32 v21, v21
  v_exp_f32 v22, v22
  v_exp_f32 v23, v23
  v_pk_mul_f32 v[192:193], v[192:193], v[200:201]
  v_pk_mul_f32 v[194:195], v[194:195], v[202:203]
  v_pk_mul_f32 v[196:197], v[196:197], v[204:205]
  v_pk_mul_f32 v[198:199], v[198:199], v[206:207]
  v_pk_add_f32 v[16:17], v[16:17], s[90:91]
  v_pk_add_f32 v[18:19], v[18:19], s[90:91]
  v_pk_add_f32 v[20:21], v[20:21], s[90:91]
  v_pk_add_f32 v[22:23], v[22:23], s[90:91]
  v_rcp_f32 v16, v16
  v_rcp_f32 v17, v17
  v_rcp_f32 v18, v18
  v_rcp_f32 v19, v19
  v_rcp_f32 v20, v20
  v_rcp_f32 v21, v21
  v_rcp_f32 v22, v22
  v_rcp_f32 v23, v23
  v_pk_mul_f32 v[192:193], v[192:193], v[16:17]
  v_pk_mul_f32 v[194:195], v[194:195], v[18:19]
  v_pk_mul_f32 v[196:197], v[196:197], v[20:21]
  v_pk_mul_f32 v[198:199], v[198:199], v[22:23]
  v_cvt_pk_bf16_f32 v36, v192, v193
  v_cvt_pk_bf16_f32 v37, v194, v195
  v_cvt_pk_bf16_f32 v38, v196, v197
  v_cvt_pk_bf16_f32 v39, v198, v199
  buffer_store_dwordx4 v[36:39], v83, s[40:43], s3 offen offset:0 sc1
  v_pk_mul_f32 v[16:17], v[224:225], s[88:89]
  v_pk_mul_f32 v[18:19], v[226:227], s[88:89]
  v_pk_mul_f32 v[20:21], v[228:229], s[88:89]
  v_pk_mul_f32 v[22:23], v[230:231], s[88:89]
  v_exp_f32 v16, v16
  v_exp_f32 v17, v17
  v_exp_f32 v18, v18
  v_exp_f32 v19, v19
  v_exp_f32 v20, v20
  v_exp_f32 v21, v21
  v_exp_f32 v22, v22
  v_exp_f32 v23, v23
  v_pk_mul_f32 v[224:225], v[224:225], v[232:233]
  v_pk_mul_f32 v[226:227], v[226:227], v[234:235]
  v_pk_mul_f32 v[228:229], v[228:229], v[236:237]
  v_pk_mul_f32 v[230:231], v[230:231], v[238:239]
  v_pk_add_f32 v[16:17], v[16:17], s[90:91]
  v_pk_add_f32 v[18:19], v[18:19], s[90:91]
  v_pk_add_f32 v[20:21], v[20:21], s[90:91]
  v_pk_add_f32 v[22:23], v[22:23], s[90:91]
  v_rcp_f32 v16, v16
  v_rcp_f32 v17, v17
  v_rcp_f32 v18, v18
  v_rcp_f32 v19, v19
  v_rcp_f32 v20, v20
  v_rcp_f32 v21, v21
  v_rcp_f32 v22, v22
  v_rcp_f32 v23, v23
  v_pk_mul_f32 v[224:225], v[224:225], v[16:17]
  v_pk_mul_f32 v[226:227], v[226:227], v[18:19]
  v_pk_mul_f32 v[228:229], v[228:229], v[20:21]
  v_pk_mul_f32 v[230:231], v[230:231], v[22:23]
  v_cvt_pk_bf16_f32 v40, v224, v225
  v_cvt_pk_bf16_f32 v41, v226, v227
  v_cvt_pk_bf16_f32 v42, v228, v229
  v_cvt_pk_bf16_f32 v43, v230, v231
  buffer_store_dwordx4 v[40:43], v83, s[40:43], s3 offen offset:1024 sc1
  v_pk_mul_f32 v[16:17], v[208:209], s[88:89]
  v_pk_mul_f32 v[18:19], v[210:211], s[88:89]
  v_pk_mul_f32 v[20:21], v[212:213], s[88:89]
  v_pk_mul_f32 v[22:23], v[214:215], s[88:89]
  v_exp_f32 v16, v16
  v_exp_f32 v17, v17
  v_exp_f32 v18, v18
  v_exp_f32 v19, v19
  v_exp_f32 v20, v20
  v_exp_f32 v21, v21
  v_exp_f32 v22, v22
  v_exp_f32 v23, v23
  v_pk_mul_f32 v[208:209], v[208:209], v[216:217]
  v_pk_mul_f32 v[210:211], v[210:211], v[218:219]
  v_pk_mul_f32 v[212:213], v[212:213], v[220:221]
  v_pk_mul_f32 v[214:215], v[214:215], v[222:223]
  v_pk_add_f32 v[16:17], v[16:17], s[90:91]
  v_pk_add_f32 v[18:19], v[18:19], s[90:91]
  v_pk_add_f32 v[20:21], v[20:21], s[90:91]
  v_pk_add_f32 v[22:23], v[22:23], s[90:91]
  v_rcp_f32 v16, v16
  v_rcp_f32 v17, v17
  v_rcp_f32 v18, v18
  v_rcp_f32 v19, v19
  v_rcp_f32 v20, v20
  v_rcp_f32 v21, v21
  v_rcp_f32 v22, v22
  v_rcp_f32 v23, v23
  v_pk_mul_f32 v[208:209], v[208:209], v[16:17]
  v_pk_mul_f32 v[210:211], v[210:211], v[18:19]
  v_pk_mul_f32 v[212:213], v[212:213], v[20:21]
  v_pk_mul_f32 v[214:215], v[214:215], v[22:23]
  v_cvt_pk_bf16_f32 v44, v208, v209
  v_cvt_pk_bf16_f32 v45, v210, v211
  v_cvt_pk_bf16_f32 v46, v212, v213
  v_cvt_pk_bf16_f32 v47, v214, v215
  buffer_store_dwordx4 v[44:47], v83, s[40:43], s79 offen offset:0 sc1
  v_pk_mul_f32 v[16:17], v[240:241], s[88:89]
  v_pk_mul_f32 v[18:19], v[242:243], s[88:89]
  v_pk_mul_f32 v[20:21], v[244:245], s[88:89]
  v_pk_mul_f32 v[22:23], v[246:247], s[88:89]
  v_exp_f32 v16, v16
  v_exp_f32 v17, v17
  v_exp_f32 v18, v18
  v_exp_f32 v19, v19
  v_exp_f32 v20, v20
  v_exp_f32 v21, v21
  v_exp_f32 v22, v22
  v_exp_f32 v23, v23
  v_pk_mul_f32 v[240:241], v[240:241], v[248:249]
  v_pk_mul_f32 v[242:243], v[242:243], v[250:251]
  v_pk_mul_f32 v[244:245], v[244:245], v[252:253]
  v_pk_mul_f32 v[246:247], v[246:247], v[254:255]
  v_pk_add_f32 v[16:17], v[16:17], s[90:91]
  v_pk_add_f32 v[18:19], v[18:19], s[90:91]
  v_pk_add_f32 v[20:21], v[20:21], s[90:91]
  v_pk_add_f32 v[22:23], v[22:23], s[90:91]
  v_rcp_f32 v16, v16
  v_rcp_f32 v17, v17
  v_rcp_f32 v18, v18
  v_rcp_f32 v19, v19
  v_rcp_f32 v20, v20
  v_rcp_f32 v21, v21
  v_rcp_f32 v22, v22
  v_rcp_f32 v23, v23
  v_pk_mul_f32 v[240:241], v[240:241], v[16:17]
  v_pk_mul_f32 v[242:243], v[242:243], v[18:19]
  v_pk_mul_f32 v[244:245], v[244:245], v[20:21]
  v_pk_mul_f32 v[246:247], v[246:247], v[22:23]
  v_cvt_pk_bf16_f32 v48, v240, v241
  v_cvt_pk_bf16_f32 v49, v242, v243
  v_cvt_pk_bf16_f32 v50, v244, v245
  v_cvt_pk_bf16_f32 v51, v246, v247
  buffer_store_dwordx4 v[48:51], v83, s[40:43], s79 offen offset:1024 sc1
  s_endpgm
K1_TYPEB:
  v_mul_u32_u24 v8, 10368, v10
  v_mul_u32_u24 v9, 160, v13
  v_add3_u32 v8, v8, v9, v14
  v_add_u32 v78, 32768, v8
  s_mul_i32 s79, s76, 160
  s_add_u32 s79, s79, 1024
  s_lshl_b32 s3, s74, 6
  v_add_u32 v8, s3, v0
  v_mul_u32_u24 v9, 6554, v8
  v_lshrrev_b32 v9, 16, v9
  v_mul_u32_u24 v10, 10, v9
  v_sub_u32 v10, v8, v10
  v_mul_u32_u24 v9, 3584, v9
  v_lshl_add_u32 v9, v10, 4, v9
  v_add_u32 v4, s79, v9
  s_mov_b32 s64, 0
  s_lshl_b32 s69, s74, 10
  s_add_u32 s69, s69, 32768
  s_add_u32 s80, s74, 4
  s_lshl_b32 s3, s80, 6
  v_add_u32 v8, s3, v0
  v_mul_u32_u24 v9, 6554, v8
  v_lshrrev_b32 v9, 16, v9
  v_mul_u32_u24 v10, 10, v9
  v_sub_u32 v10, v8, v10
  v_mul_u32_u24 v9, 3584, v9
  v_lshl_add_u32 v9, v10, 4, v9
  v_add_u32 v5, s79, v9
  s_mov_b32 s65, 0
  s_lshl_b32 s70, s80, 10
  s_add_u32 s70, s70, 32768
  s_add_u32 s80, s74, 8
  s_sub_u32 s81, s74, 2
  s_cmp_lt_u32 s74, 2
  s_cselect_b32 s80, s80, s81
  s_cselect_b64 s[60:61], s[32:33], s[36:37]
  s_cselect_b64 s[62:63], s[34:35], s[38:39]
  s_mov_b32 s81, 43136
  s_cselect_b32 s81, 32768, s81
  s_lshl_b32 s3, s80, 6
  v_add_u32 v8, s3, v0
  v_mul_u32_u24 v9, 6554, v8
  v_lshrrev_b32 v9, 16, v9
  v_mul_u32_u24 v10, 10, v9
  v_sub_u32 v10, v8, v10
  v_mul_u32_u24 v9, 3584, v9
  v_lshl_add_u32 v9, v10, 4, v9
  v_add_u32 v6, s79, v9
  s_mov_b32 s66, 0
  s_lshl_b32 s71, s80, 10
  s_add_u32 s71, s71, s81
  s_add_u32 s80, s74, 2
  s_lshl_b32 s3, s80, 6
  v_add_u32 v8, s3, v0
  v_mul_u32_u24 v9, 6554, v8
  v_lshrrev_b32 v9, 16, v9
  v_mul_u32_u24 v10, 10, v9
  v_sub_u32 v10, v8, v10
  v_mul_u32_u24 v9, 3584, v9
  v_lshl_add_u32 v9, v10, 4, v9
  v_add_u32 v7, s79, v9
  s_mov_b32 s67, 0
  s_lshl_b32 s72, s80, 10
  s_add_u32 s72, s72, 43136
  s_add_u32 s80, s74, 6
  s_lshl_b32 s3, s80, 6
  v_add_u32 v8, s3, v0
  v_mul_u32_u24 v9, 6554, v8
  v_lshrrev_b32 v9, 16, v9
  v_mul_u32_u24 v10, 10, v9
  v_sub_u32 v10, v8, v10
  v_mul_u32_u24 v9, 3584, v9
  v_lshl_add_u32 v9, v10, 4, v9
  v_add_u32 v72, s79, v9
  s_mov_b32 s68, 0
  s_lshl_b32 s73, s80, 10
  s_add_u32 s73, s73, 43136
  s_mul_i32 s3, s83, 229376
  s_add_u32 s64, s64, s3
  s_mul_i32 s3, s83, 229376
  s_add_u32 s65, s65, s3
  s_mul_i32 s3, s83, 229376
  s_add_u32 s66, s66, s3
  s_mul_i32 s3, s83, 229376
  s_add_u32 s67, s67, s3
  s_mul_i32 s3, s83, 229376
  s_add_u32 s68, s68, s3
  s_cmp_lt_u32 s82, 4
  s_cbranch_scc1 K1B_COMPUTE
  s_mov_b32 s10, 0
  s_add_u32 s11, s78, s10
  s_add_u32 m0, s11, 0
  s_add_u32 s79, s94, 0
  buffer_load_dwordx4 v2, s[24:27], s79 offen lds
  s_add_u32 m0, s11, 1024
  s_add_u32 s79, s94, 7168
  buffer_load_dwordx4 v3, s[24:27], s79 offen lds
  s_add_u32 m0, s11, 2048
  s_add_u32 s79, s94, 14336
  buffer_load_dwordx4 v2, s[24:27], s79 offen lds
  s_add_u32 m0, s11, 3072
  s_add_u32 s79, s94, 21504
  buffer_load_dwordx4 v3, s[24:27], s79 offen lds
  s_add_u32 m0, s11, 4096
  s_add_u32 s79, s94, 28672
  buffer_load_dwordx4 v2, s[24:27], s79 offen lds
  s_add_u32 m0, s11, 5120
  s_add_u32 s79, s94, 35840
  buffer_load_dwordx4 v3, s[24:27], s79 offen lds
  s_add_u32 m0, s11, 6144
  s_add_u32 s79, s94, 43008
  buffer_load_dwordx4 v2, s[24:27], s79 offen lds
  s_add_u32 m0, s11, 7168
  s_add_u32 s79, s94, 50176
  buffer_load_dwordx4 v3, s[24:27], s79 offen lds
  s_add_u32 s94, s94, 128
  s_add_u32 m0, s69, s10
  s_nop 0
  buffer_load_dwordx4 v4, s[32:35], s64 offen lds
  s_add_u32 s64, s64, 229376
  s_add_u32 m0, s70, s10
  s_nop 0
  buffer_load_dwordx4 v5, s[32:35], s65 offen lds
  s_add_u32 s65, s65, 229376
  s_add_u32 m0, s71, s10
  s_nop 0
  buffer_load_dwordx4 v6, s[60:63], s66 offen lds
  s_add_u32 s66, s66, 229376
  s_add_u32 m0, s72, s10
  s_nop 0
  buffer_load_dwordx4 v7, s[36:39], s67 offen lds
  s_add_u32 s67, s67, 229376
  s_add_u32 m0, s73, s10
  s_nop 0
  buffer_load_dwordx4 v72, s[36:39], s68 offen lds
  s_add_u32 s68, s68, 229376
  s_add_u32 s10, s10, 53376
  s_cmp_eq_u32 s10, 160128
  s_cselect_b32 s10, 0, s10
  s_add_u32 s11, s78, s10
  s_add_u32 m0, s11, 0
  s_add_u32 s79, s94, 0
  buffer_load_dwordx4 v2, s[24:27], s79 offen lds
  s_add_u32 m0, s11, 1024
  s_add_u32 s79, s94, 7168
  buffer_load_dwordx4 v3, s[24:27], s79 offen lds
  s_add_u32 m0, s11, 2048
  s_add_u32 s79, s94, 14336
  buffer_load_dwordx4 v2, s[24:27], s79 offen lds
  s_add_u32 m0, s11, 3072
  s_add_u32 s79, s94, 21504
  buffer_load_dwordx4 v3, s[24:27], s79 offen lds
  s_add_u32 m0, s11, 4096
  s_add_u32 s79, s94, 28672
  buffer_load_dwordx4 v2, s[24:27], s79 offen lds
  s_add_u32 m0, s11, 5120
  s_add_u32 s79, s94, 35840
  buffer_load_dwordx4 v3, s[24:27], s79 offen lds
  s_add_u32 m0, s11, 6144
  s_add_u32 s79, s94, 43008
  buffer_load_dwordx4 v2, s[24:27], s79 offen lds
  s_add_u32 m0, s11, 7168
  s_add_u32 s79, s94, 50176
  buffer_load_dwordx4 v3, s[24:27], s79 offen lds
  s_add_u32 s94, s94, 128
  s_add_u32 m0, s69, s10
  s_nop 0
  buffer_load_dwordx4 v4, s[32:35], s64 offen lds
  s_add_u32 s64, s64, 229376
  s_add_u32 m0, s70, s10
  s_nop 0
  buffer_load_dwordx4 v5, s[32:35], s65 offen lds
  s_add_u32 s65, s65, 229376
  s_add_u32 m0, s71, s10
  s_nop 0
  buffer_load_dwordx4 v6, s[60:63], s66 offen lds
  s_add_u32 s66, s66, 229376
  s_add_u32 m0, s72, s10
  s_nop 0
  buffer_load_dwordx4 v7, s[36:39], s67 offen lds
  s_add_u32 s67, s67, 229376
  s_add_u32 m0, s73, s10
  s_nop 0
  buffer_load_dwordx4 v72, s[36:39], s68 offen lds
  s_add_u32 s68, s68, 229376
  s_add_u32 s10, s10, 53376
  s_cmp_eq_u32 s10, 160128
  s_cselect_b32 s10, 0, s10
  s_waitcnt vmcnt(13) lgkmcnt(0)
  s_barrier
  s_add_u32 s11, s78, s10
  s_add_u32 m0, s11, 0
  s_add_u32 s79, s94, 0
  buffer_load_dwordx4 v2, s[24:27], s79 offen lds
  s_add_u32 m0, s11, 1024
  s_add_u32 s79, s94, 7168
  buffer_load_dwordx4 v3, s[24:27], s79 offen lds
  s_add_u32 m0, s11, 2048
  s_add_u32 s79, s94, 14336
  buffer_load_dwordx4 v2, s[24:27], s79 offen lds
  s_add_u32 m0, s11, 3072
  s_add_u32 s79, s94, 21504
  buffer_load_dwordx4 v3, s[24:27], s79 offen lds
  s_add_u32 m0, s11, 4096
  s_add_u32 s79, s94, 28672
  buffer_load_dwordx4 v2, s[24:27], s79 offen lds
  s_add_u32 m0, s11, 5120
  s_add_u32 s79, s94, 35840
  buffer_load_dwordx4 v3, s[24:27], s79 offen lds
  s_add_u32 m0, s11, 6144
  s_add_u32 s79, s94, 43008
  buffer_load_dwordx4 v2, s[24:27], s79 offen lds
  s_add_u32 m0, s11, 7168
  s_add_u32 s79, s94, 50176
  buffer_load_dwordx4 v3, s[24:27], s79 offen lds
  s_add_u32 s94, s94, 128
  s_add_u32 m0, s69, s10
  s_nop 0
  buffer_load_dwordx4 v4, s[32:35], s64 offen lds
  s_add_u32 s64, s64, 229376
  s_add_u32 m0, s70, s10
  s_nop 0
  buffer_load_dwordx4 v5, s[32:35], s65 offen lds
  s_add_u32 s65, s65, 229376
  s_add_u32 m0, s71, s10
  s_nop 0
  buffer_load_dwordx4 v6, s[60:63], s66 offen lds
  s_add_u32 s66, s66, 229376
  s_add_u32 m0, s72, s10
  s_nop 0
  buffer_load_dwordx4 v7, s[36:39], s67 offen lds
  s_add_u32 s67, s67, 229376
  s_add_u32 m0, s73, s10
  s_nop 0
  buffer_load_dwordx4 v72, s[36:39], s68 offen lds
  s_add_u32 s68, s68, 229376
  s_add_u32 s10, s10, 53376
  s_cmp_eq_u32 s10, 160128
  s_cselect_b32 s10, 0, s10
  s_mov_b32 s12, 0
K1B_LLOOP:
  s_waitcnt vmcnt(13)
  s_barrier
  s_add_u32 s11, s78, s10
  s_add_u32 m0, s11, 0
  s_add_u32 s79, s94, 0
  buffer_load_dwordx4 v2, s[24:27], s79 offen lds
  s_add_u32 m0, s11, 1024
  s_add_u32 s79, s94, 7168
  buffer_load_dwordx4 v3, s[24:27], s79 offen lds
  s_add_u32 m0, s11, 2048
  s_add_u32 s79, s94, 14336
  buffer_load_dwordx4 v2, s[24:27], s79 offen lds
  s_add_u32 m0, s11, 3072
  s_add_u32 s79, s94, 21504
  buffer_load_dwordx4 v3, s[24:27], s79 offen lds
  s_add_u32 m0, s11, 4096
  s_add_u32 s79, s94, 28672
  buffer_load_dwordx4 v2, s[24:27], s79 offen lds
  s_add_u32 m0, s11, 5120
  s_add_u32 s79, s94, 35840
  buffer_load_dwordx4 v3, s[24:27], s79 offen lds
  s_add_u32 m0, s11, 6144
  s_add_u32 s79, s94, 43008
  buffer_load_dwordx4 v2, s[24:27], s79 offen lds
  s_add_u32 m0, s11, 7168
  s_add_u32 s79, s94, 50176
  buffer_load_dwordx4 v3, s[24:27], s79 offen lds
  s_add_u32 s94, s94, 128
  s_add_u32 m0, s69, s10
  s_nop 0
  buffer_load_dwordx4 v4, s[32:35], s64 offen lds
  s_add_u32 s64, s64, 229376
  s_add_u32 m0, s70, s10
  s_nop 0
  buffer_load_dwordx4 v5, s[32:35], s65 offen lds
  s_add_u32 s65, s65, 229376
  s_add_u32 m0, s71, s10
  s_nop 0
  buffer_load_dwordx4 v6, s[60:63], s66 offen lds
  s_add_u32 s66, s66, 229376
  s_add_u32 m0, s72, s10
  s_nop 0
  buffer_load_dwordx4 v7, s[36:39], s67 offen lds
  s_add_u32 s67, s67, 229376
  s_add_u32 m0, s73, s10
  s_nop 0
  buffer_load_dwordx4 v72, s[36:39], s68 offen lds
  s_add_u32 s68, s68, 229376
  s_add_u32 s10, s10, 53376
  s_cmp_eq_u32 s10, 160128
  s_cselect_b32 s10, 0, s10
  s_add_u32 s12, s12, 1
  s_cmp_lt_u32 s12, 4
  s_cbranch_scc1 K1B_LLOOP
  s_waitcnt vmcnt(13)
  s_barrier
  s_lshl_b32 s10, s74, 12
  s_add_u32 s10, s10, 53376
  v_lshrrev_b32 v8, 2, v0
  v_mul_u32_u24 v8, 896, v8
  v_and_b32 v9, 3, v0
  v_lshl_add_u32 v8, v9, 4, v8
  s_lshl_b32 s79, s75, 4
  s_add_u32 s79, s79, s76
  s_lshl_b32 s79, s79, 2
  s_add_u32 s79, s79, s74
  s_lshl_b32 s79, s79, 1
  s_add_u32 s79, s79, 0
  s_min_u32 s79, s79, 1007
  s_cmp_ge_u32 s79, 784
  s_cselect_b32 s6, 1, 0
  s_cselect_b32 s80, 784, 0
  s_sub_u32 s79, s79, s80
  s_mul_i32 s5, s79, 4682
  s_lshr_b32 s5, s5, 16
  s_mul_i32 s80, s5, 14
  s_sub_u32 s4, s79, s80
  s_cmp_eq_u32 s6, 1
  s_cselect_b32 s80, 28, 32
  s_mul_i32 s80, s80, s5
  s_mul_i32 s80, s80, 896
  s_lshl_b32 s81, s4, 6
  s_add_u32 s80, s80, s81
  s_cmp_eq_u32 s6, 1
  s_cselect_b64 s[60:61], s[48:49], s[44:45]
  s_cselect_b64 s[62:63], s[50:51], s[46:47]
  s_add_u32 m0, s10, 0
  s_add_u32 s81, s80, 14336
  buffer_load_dwordx4 v8, s[60:63], s80 offen lds
  s_add_u32 m0, s10, 1024
  s_nop 0
  buffer_load_dwordx4 v8, s[60:63], s81 offen lds
  s_lshl_b32 s79, s75, 4
  s_add_u32 s79, s79, s76
  s_lshl_b32 s79, s79, 2
  s_add_u32 s79, s79, s74
  s_lshl_b32 s79, s79, 1
  s_add_u32 s79, s79, 1
  s_min_u32 s79, s79, 1007
  s_cmp_ge_u32 s79, 784
  s_cselect_b32 s9, 1, 0
  s_cselect_b32 s80, 784, 0
  s_sub_u32 s79, s79, s80
  s_mul_i32 s8, s79, 4682
  s_lshr_b32 s8, s8, 16
  s_mul_i32 s80, s8, 14
  s_sub_u32 s7, s79, s80
  s_cmp_eq_u32 s9, 1
  s_cselect_b32 s80, 28, 32
  s_mul_i32 s80, s80, s8
  s_mul_i32 s80, s80, 896
  s_lshl_b32 s81, s7, 6
  s_add_u32 s80, s80, s81
  s_cmp_eq_u32 s9, 1
  s_cselect_b64 s[60:61], s[48:49], s[44:45]
  s_cselect_b64 s[62:63], s[50:51], s[46:47]
  s_add_u32 m0, s10, 2048
  s_add_u32 s81, s80, 14336
  buffer_load_dwordx4 v8, s[60:63], s80 offen lds
  s_add_u32 m0, s10, 3072
  s_nop 0
  buffer_load_dwordx4 v8, s[60:63], s81 offen lds
  s_waitcnt vmcnt(4)
  s_barrier
  v_lshrrev_b32 v9, 5, v0
  v_bfe_u32 v10, v0, 4, 1
  v_bfe_u32 v11, v0, 2, 2
  v_and_b32 v12, 3, v0
  v_lshl_add_u32 v15, v10, 2, v12
  v_and_b32 v13, 1, v15
  v_lshlrev_b32 v13, 2, v13
  v_lshrrev_b32 v14, 1, v15
  v_add_u32 v13, v13, v14
  v_lshlrev_b32 v13, 3, v13
  s_waitcnt vmcnt(0)
  s_cmp_eq_u32 s6, 1
  s_cselect_b32 s79, 2, 3
  s_mov_b32 s80, 256
  s_cselect_b32 s80, 512, s80
  v_lshlrev_b32 v14, s79, v9
  v_add_u32 v14, v14, v11
  v_lshl_add_u32 v14, v14, 6, v13
  v_add_u32 v14, s10, v14
  v_add_u32 v15, s80, v14
  ds_read_b64_tr_b16 v[96:97], v14 offset:0
  ds_read_b64_tr_b16 v[98:99], v15 offset:0
  ds_read_b64_tr_b16 v[100:101], v14 offset:1024
  ds_read_b64_tr_b16 v[102:103], v15 offset:1024
  s_mul_i32 s79, s4, 112
  s_lshl_b32 s80, s5, 1
  s_add_u32 s79, s79, s80
  s_lshl_b32 s79, s79, 10
  s_add_u32 s79, s79, 9994240
  s_lshl_b32 s81, s4, 4
  s_add_u32 s81, s81, s5
  s_lshl_b32 s81, s81, 11
  s_add_u32 s81, s81, 11599872
  s_cmp_eq_u32 s6, 1
  s_cselect_b32 s79, s81, s79
  s_cselect_b32 s80, 32, 64
  v_cmp_le_u32 vcc, s80, v0
  s_waitcnt lgkmcnt(0)
  s_nop 0
  v_cndmask_b32 v102, v102, 0, vcc
  v_cndmask_b32 v103, v103, 0, vcc
  buffer_store_dwordx4 v[96:99], v83, s[40:43], s79 offen sc1
  buffer_store_dwordx4 v[100:103], v83, s[40:43], s79 offen offset:1024 sc1
  s_cmp_eq_u32 s9, 1
  s_cselect_b32 s79, 2, 3
  s_mov_b32 s80, 256
  s_cselect_b32 s80, 512, s80
  v_lshlrev_b32 v14, s79, v9
  v_add_u32 v14, v14, v11
  v_lshl_add_u32 v14, v14, 6, v13
  v_add_u32 v14, s10, v14
  v_add_u32 v15, s80, v14
  ds_read_b64_tr_b16 v[104:105], v14 offset:2048
  ds_read_b64_tr_b16 v[106:107], v15 offset:2048
  ds_read_b64_tr_b16 v[108:109], v14 offset:3072
  ds_read_b64_tr_b16 v[110:111], v15 offset:3072
  s_mul_i32 s79, s7, 112
  s_lshl_b32 s80, s8, 1
  s_add_u32 s79, s79, s80
  s_lshl_b32 s79, s79, 10
  s_add_u32 s79, s79, 9994240
  s_lshl_b32 s81, s7, 4
  s_add_u32 s81, s81, s8
  s_lshl_b32 s81, s81, 11
  s_add_u32 s81, s81, 11599872
  s_cmp_eq_u32 s9, 1
  s_cselect_b32 s79, s81, s79
  s_cselect_b32 s80, 32, 64
  v_cmp_le_u32 vcc, s80, v0
  s_waitcnt lgkmcnt(0)
  s_nop 0
  v_cndmask_b32 v110, v110, 0, vcc
  v_cndmask_b32 v111, v111, 0, vcc
  buffer_store_dwordx4 v[104:107], v83, s[40:43], s79 offen sc1
  buffer_store_dwordx4 v[108:111], v83, s[40:43], s79 offen offset:1024 sc1
  s_endpgm
K1B_COMPUTE:
  s_barrier
  ds_read_b128 v[56:59], v73
  ds_read_b128 v[60:63], v73 offset:4096
  ds_read_b64_tr_b16 v[16:17], v78 offset:0
  ds_read_b64_tr_b16 v[18:19], v78 offset:640
  ds_read_b64_tr_b16 v[20:21], v78 offset:32
  ds_read_b64_tr_b16 v[22:23], v78 offset:672
  ds_read_b64_tr_b16 v[24:25], v78 offset:64
  ds_read_b64_tr_b16 v[26:27], v78 offset:704
  ds_read_b64_tr_b16 v[28:29], v78 offset:96
  ds_read_b64_tr_b16 v[30:31], v78 offset:736
  ds_read_b64_tr_b16 v[32:33], v78 offset:128
  ds_read_b64_tr_b16 v[34:35], v78 offset:768
  s_mov_b32 s4, 0
  s_mov_b32 s5, 0
  s_waitcnt lgkmcnt(0)
  v_mfma_f32_32x32x16_bf16 v[96:111], v[16:19], v[56:59], 0
  ds_read_b128 v[64:67], v74
  ds_read_b128 v[68:71], v74 offset:4096
  v_mfma_f32_32x32x16_bf16 v[112:127], v[16:19], v[60:63], 0
  ds_read_b64_tr_b16 v[36:37], v78 offset:2560
  ds_read_b64_tr_b16 v[38:39], v78 offset:3200
  v_mfma_f32_32x32x16_bf16 v[128:143], v[20:23], v[56:59], 0
  ds_read_b64_tr_b16 v[40:41], v78 offset:2592
  ds_read_b64_tr_b16 v[42:43], v78 offset:3232
  v_mfma_f32_32x32x16_bf16 v[144:159], v[20:23], v[60:63], 0
  ds_read_b64_tr_b16 v[44:45], v78 offset:2624
  ds_read_b64_tr_b16 v[46:47], v78 offset:3264
  v_mfma_f32_32x32x16_bf16 v[160:175], v[24:27], v[56:59], 0
  ds_read_b64_tr_b16 v[48:49], v78 offset:2656
  ds_read_b64_tr_b16 v[50:51], v78 offset:3296
  v_mfma_f32_32x32x16_bf16 v[176:191], v[24:27], v[60:63], 0
  ds_read_b64_tr_b16 v[52:53], v78 offset:2688
  ds_read_b64_tr_b16 v[54:55], v78 offset:3328
  v_mfma_f32_32x32x16_bf16 v[192:207], v[28:31], v[56:59], 0
  v_mfma_f32_32x32x16_bf16 v[208:223], v[28:31], v[60:63], 0
  v_mfma_f32_32x32x16_bf16 v[224:239], v[32:35], v[56:59], 0
  v_mfma_f32_32x32x16_bf16 v[240:255], v[32:35], v[60:63], 0
K1B_LOOP:
  s_waitcnt lgkmcnt(0)
  v_mfma_f32_32x32x16_bf16 v[96:111], v[36:39], v[64:67], v[96:111]
  ds_read_b128 v[56:59], v75
  ds_read_b128 v[60:63], v75 offset:4096
  v_mfma_f32_32x32x16_bf16 v[112:127], v[36:39], v[68:71], v[112:127]
  ds_read_b64_tr_b16 v[16:17], v78 offset:5120
  ds_read_b64_tr_b16 v[18:19], v78 offset:5760
  v_mfma_f32_32x32x16_bf16 v[128:143], v[40:43], v[64:67], v[128:143]
  ds_read_b64_tr_b16 v[20:21], v78 offset:5152
  ds_read_b64_tr_b16 v[22:23], v78 offset:5792
  v_mfma_f32_32x32x16_bf16 v[144:159], v[40:43], v[68:71], v[144:159]
  ds_read_b64_tr_b16 v[24:25], v78 offset:5184
  ds_read_b64_tr_b16 v[26:27], v78 offset:5824
  v_mfma_f32_32x32x16_bf16 v[160:175], v[44:47], v[64:67], v[160:175]
  ds_read_b64_tr_b16 v[28:29], v78 offset:5216
  ds_read_b64_tr_b16 v[30:31], v78 offset:5856
  v_mfma_f32_32x32x16_bf16 v[176:191], v[44:47], v[68:71], v[176:191]
  ds_read_b64_tr_b16 v[32:33], v78 offset:5248
  ds_read_b64_tr_b16 v[34:35], v78 offset:5888
  v_mfma_f32_32x32x16_bf16 v[192:207], v[48:51], v[64:67], v[192:207]
  v_mfma_f32_32x32x16_bf16 v[208:223], v[48:51], v[68:71], v[208:223]
  v_mfma_f32_32x32x16_bf16 v[224:239], v[52:55], v[64:67], v[224:239]
  v_mfma_f32_32x32x16_bf16 v[240:255], v[52:55], v[68:71], v[240:255]
  s_waitcnt lgkmcnt(0)
  v_mfma_f32_32x32x16_bf16 v[96:111], v[16:19], v[56:59], v[96:111]
  ds_read_b128 v[64:67], v76
  ds_read_b128 v[68:71], v76 offset:4096
  v_mfma_f32_32x32x16_bf16 v[112:127], v[16:19], v[60:63], v[112:127]
  ds_read_b64_tr_b16 v[36:37], v78 offset:7680
  ds_read_b64_tr_b16 v[38:39], v78 offset:8320
  v_mfma_f32_32x32x16_bf16 v[128:143], v[20:23], v[56:59], v[128:143]
  ds_read_b64_tr_b16 v[40:41], v78 offset:7712
  ds_read_b64_tr_b16 v[42:43], v78 offset:8352
  v_mfma_f32_32x32x16_bf16 v[144:159], v[20:23], v[60:63], v[144:159]
  ds_read_b64_tr_b16 v[44:45], v78 offset:7744
  ds_read_b64_tr_b16 v[46:47], v78 offset:8384
  v_mfma_f32_32x32x16_bf16 v[160:175], v[24:27], v[56:59], v[160:175]
  ds_read_b64_tr_b16 v[48:49], v78 offset:7776
  ds_read_b64_tr_b16 v[50:51], v78 offset:8416
  v_mfma_f32_32x32x16_bf16 v[176:191], v[24:27], v[60:63], v[176:191]
  ds_read_b64_tr_b16 v[52:53], v78 offset:7808
  ds_read_b64_tr_b16 v[54:55], v78 offset:8448
  v_mfma_f32_32x32x16_bf16 v[192:207], v[28:31], v[56:59], v[192:207]
  v_mfma_f32_32x32x16_bf16 v[208:223], v[28:31], v[60:63], v[208:223]
  v_mfma_f32_32x32x16_bf16 v[224:239], v[32:35], v[56:59], v[224:239]
  v_mfma_f32_32x32x16_bf16 v[240:255], v[32:35], v[60:63], v[240:255]
  s_waitcnt lgkmcnt(0)
  s_cmp_eq_u32 s4, 6
  s_cbranch_scc1 K1B_NOBAR
  s_barrier
K1B_NOBAR:
  v_mfma_f32_32x32x16_bf16 v[96:111], v[36:39], v[64:67], v[96:111]
  s_add_u32 s5, s5, 1
  s_cmp_eq_u32 s5, 3
  s_cselect_b32 s5, 0, s5
  s_mov_b32 s6, 53376
  s_cselect_b32 s6, 0xfffe5f00, s6
  v_add_u32 v73, s6, v73
  v_add_u32 v74, s6, v74
  v_add_u32 v75, s6, v75
  v_add_u32 v76, s6, v76
  v_add_u32 v78, s6, v78
  ds_read_b128 v[56:59], v73
  ds_read_b128 v[60:63], v73 offset:4096
  v_mfma_f32_32x32x16_bf16 v[112:127], v[36:39], v[68:71], v[112:127]
  ds_read_b64_tr_b16 v[16:17], v78 offset:0
  ds_read_b64_tr_b16 v[18:19], v78 offset:640
  v_mfma_f32_32x32x16_bf16 v[128:143], v[40:43], v[64:67], v[128:143]
  ds_read_b64_tr_b16 v[20:21], v78 offset:32
  ds_read_b64_tr_b16 v[22:23], v78 offset:672
  v_mfma_f32_32x32x16_bf16 v[144:159], v[40:43], v[68:71], v[144:159]
  ds_read_b64_tr_b16 v[24:25], v78 offset:64
  ds_read_b64_tr_b16 v[26:27], v78 offset:704
  v_mfma_f32_32x32x16_bf16 v[160:175], v[44:47], v[64:67], v[160:175]
  ds_read_b64_tr_b16 v[28:29], v78 offset:96
  ds_read_b64_tr_b16 v[30:31], v78 offset:736
  v_mfma_f32_32x32x16_bf16 v[176:191], v[44:47], v[68:71], v[176:191]
  ds_read_b64_tr_b16 v[32:33], v78 offset:128
  ds_read_b64_tr_b16 v[34:35], v78 offset:768
  v_mfma_f32_32x32x16_bf16 v[192:207], v[48:51], v[64:67], v[192:207]
  v_mfma_f32_32x32x16_bf16 v[208:223], v[48:51], v[68:71], v[208:223]
  v_mfma_f32_32x32x16_bf16 v[224:239], v[52:55], v[64:67], v[224:239]
  v_mfma_f32_32x32x16_bf16 v[240:255], v[52:55], v[68:71], v[240:255]
  s_cmp_eq_u32 s4, 6
  s_cbranch_scc1 K1B_LOOPEND
  s_waitcnt lgkmcnt(0)
  v_mfma_f32_32x32x16_bf16 v[96:111], v[16:19], v[56:59], v[96:111]
  ds_read_b128 v[64:67], v74
  ds_read_b128 v[68:71], v74 offset:4096
  v_mfma_f32_32x32x16_bf16 v[112:127], v[16:19], v[60:63], v[112:127]
  ds_read_b64_tr_b16 v[36:37], v78 offset:2560
  ds_read_b64_tr_b16 v[38:39], v78 offset:3200
  v_mfma_f32_32x32x16_bf16 v[128:143], v[20:23], v[56:59], v[128:143]
  ds_read_b64_tr_b16 v[40:41], v78 offset:2592
  ds_read_b64_tr_b16 v[42:43], v78 offset:3232
  v_mfma_f32_32x32x16_bf16 v[144:159], v[20:23], v[60:63], v[144:159]
  ds_read_b64_tr_b16 v[44:45], v78 offset:2624
  ds_read_b64_tr_b16 v[46:47], v78 offset:3264
  v_mfma_f32_32x32x16_bf16 v[160:175], v[24:27], v[56:59], v[160:175]
  ds_read_b64_tr_b16 v[48:49], v78 offset:2656
  ds_read_b64_tr_b16 v[50:51], v78 offset:3296
  v_mfma_f32_32x32x16_bf16 v[176:191], v[24:27], v[60:63], v[176:191]
  ds_read_b64_tr_b16 v[52:53], v78 offset:2688
  ds_read_b64_tr_b16 v[54:55], v78 offset:3328
  v_mfma_f32_32x32x16_bf16 v[192:207], v[28:31], v[56:59], v[192:207]
  v_mfma_f32_32x32x16_bf16 v[208:223], v[28:31], v[60:63], v[208:223]
  v_mfma_f32_32x32x16_bf16 v[224:239], v[32:35], v[56:59], v[224:239]
  v_mfma_f32_32x32x16_bf16 v[240:255], v[32:35], v[60:63], v[240:255]
  s_add_u32 s4, s4, 1
  s_branch K1B_LOOP
K1B_LOOPEND:
  s_waitcnt lgkmcnt(0)
  s_nop 7
  s_nop 7
  s_lshl_b32 s81, s75, 3
  s_lshl_b32 s3, s74, 1
  s_add_u32 s81, s81, s3
  s_mul_i32 s3, s81, 112
  s_mul_i32 s79, s76, 5
  s_add_u32 s3, s3, s79
  s_add_u32 s3, s3, 32
  s_lshl_b32 s3, s3, 10
  s_add_u32 s3, s3, 2097152
  v_pk_mul_f32 v[16:17], v[96:97], s[88:89]
  v_pk_mul_f32 v[18:19], v[98:99], s[88:89]
  v_pk_mul_f32 v[20:21], v[100:101], s[88:89]
  v_pk_mul_f32 v[22:23], v[102:103], s[88:89]
  v_exp_f32 v16, v16
  v_exp_f32 v17, v17
  v_exp_f32 v18, v18
  v_exp_f32 v19, v19
  v_exp_f32 v20, v20
  v_exp_f32 v21, v21
  v_exp_f32 v22, v22
  v_exp_f32 v23, v23
  v_pk_mul_f32 v[96:97], v[96:97], v[104:105]
  v_pk_mul_f32 v[98:99], v[98:99], v[106:107]
  v_pk_mul_f32 v[100:101], v[100:101], v[108:109]
  v_pk_mul_f32 v[102:103], v[102:103], v[110:111]
  v_pk_add_f32 v[16:17], v[16:17], s[90:91]
  v_pk_add_f32 v[18:19], v[18:19], s[90:91]
  v_pk_add_f32 v[20:21], v[20:21], s[90:91]
  v_pk_add_f32 v[22:23], v[22:23], s[90:91]
  v_rcp_f32 v16, v16
  v_rcp_f32 v17, v17
  v_rcp_f32 v18, v18
  v_rcp_f32 v19, v19
  v_rcp_f32 v20, v20
  v_rcp_f32 v21, v21
  v_rcp_f32 v22, v22
  v_rcp_f32 v23, v23
  v_pk_mul_f32 v[96:97], v[96:97], v[16:17]
  v_pk_mul_f32 v[98:99], v[98:99], v[18:19]
  v_pk_mul_f32 v[100:101], v[100:101], v[20:21]
  v_pk_mul_f32 v[102:103], v[102:103], v[22:23]
  v_cvt_pk_bf16_f32 v36, v96, v97
  v_cvt_pk_bf16_f32 v37, v98, v99
  v_cvt_pk_bf16_f32 v38, v100, v101
  v_cvt_pk_bf16_f32 v39, v102, v103
  buffer_store_dwordx4 v[36:39], v83, s[40:43], s3 offen sc1
  s_add_u32 s3, s3, 1024
  v_pk_mul_f32 v[16:17], v[128:129], s[88:89]
  v_pk_mul_f32 v[18:19], v[130:131], s[88:89]
  v_pk_mul_f32 v[20:21], v[132:133], s[88:89]
  v_pk_mul_f32 v[22:23], v[134:135], s[88:89]
  v_exp_f32 v16, v16
  v_exp_f32 v17, v17
  v_exp_f32 v18, v18
  v_exp_f32 v19, v19
  v_exp_f32 v20, v20
  v_exp_f32 v21, v21
  v_exp_f32 v22, v22
  v_exp_f32 v23, v23
  v_pk_mul_f32 v[128:129], v[128:129], v[136:137]
  v_pk_mul_f32 v[130:131], v[130:131], v[138:139]
  v_pk_mul_f32 v[132:133], v[132:133], v[140:141]
  v_pk_mul_f32 v[134:135], v[134:135], v[142:143]
  v_pk_add_f32 v[16:17], v[16:17], s[90:91]
  v_pk_add_f32 v[18:19], v[18:19], s[90:91]
  v_pk_add_f32 v[20:21], v[20:21], s[90:91]
  v_pk_add_f32 v[22:23], v[22:23], s[90:91]
  v_rcp_f32 v16, v16
  v_rcp_f32 v17, v17
  v_rcp_f32 v18, v18
  v_rcp_f32 v19, v19
  v_rcp_f32 v20, v20
  v_rcp_f32 v21, v21
  v_rcp_f32 v22, v22
  v_rcp_f32 v23, v23
  v_pk_mul_f32 v[128:129], v[128:129], v[16:17]
  v_pk_mul_f32 v[130:131], v[130:131], v[18:19]
  v_pk_mul_f32 v[132:133], v[132:133], v[20:21]
  v_pk_mul_f32 v[134:135], v[134:135], v[22:23]
  v_cvt_pk_bf16_f32 v40, v128, v129
  v_cvt_pk_bf16_f32 v41, v130, v131
  v_cvt_pk_bf16_f32 v42, v132, v133
  v_cvt_pk_bf16_f32 v43, v134, v135
  buffer_store_dwordx4 v[40:43], v83, s[40:43], s3 offen sc1
  s_add_u32 s3, s3, 1024
  v_pk_mul_f32 v[16:17], v[160:161], s[88:89]
  v_pk_mul_f32 v[18:19], v[162:163], s[88:89]
  v_pk_mul_f32 v[20:21], v[164:165], s[88:89]
  v_pk_mul_f32 v[22:23], v[166:167], s[88:89]
  v_exp_f32 v16, v16
  v_exp_f32 v17, v17
  v_exp_f32 v18, v18
  v_exp_f32 v19, v19
  v_exp_f32 v20, v20
  v_exp_f32 v21, v21
  v_exp_f32 v22, v22
  v_exp_f32 v23, v23
  v_pk_mul_f32 v[160:161], v[160:161], v[168:169]
  v_pk_mul_f32 v[162:163], v[162:163], v[170:171]
  v_pk_mul_f32 v[164:165], v[164:165], v[172:173]
  v_pk_mul_f32 v[166:167], v[166:167], v[174:175]
  v_pk_add_f32 v[16:17], v[16:17], s[90:91]
  v_pk_add_f32 v[18:19], v[18:19], s[90:91]
  v_pk_add_f32 v[20:21], v[20:21], s[90:91]
  v_pk_add_f32 v[22:23], v[22:23], s[90:91]
  v_rcp_f32 v16, v16
  v_rcp_f32 v17, v17
  v_rcp_f32 v18, v18
  v_rcp_f32 v19, v19
  v_rcp_f32 v20, v20
  v_rcp_f32 v21, v21
  v_rcp_f32 v22, v22
  v_rcp_f32 v23, v23
  v_pk_mul_f32 v[160:161], v[160:161], v[16:17]
  v_pk_mul_f32 v[162:163], v[162:163], v[18:19]
  v_pk_mul_f32 v[164:165], v[164:165], v[20:21]
  v_pk_mul_f32 v[166:167], v[166:167], v[22:23]
  v_cvt_pk_bf16_f32 v44, v160, v161
  v_cvt_pk_bf16_f32 v45, v162, v163
  v_cvt_pk_bf16_f32 v46, v164, v165
  v_cvt_pk_bf16_f32 v47, v166, v167
  buffer_store_dwordx4 v[44:47], v83, s[40:43], s3 offen sc1
  s_add_u32 s3, s3, 1024
  v_pk_mul_f32 v[16:17], v[192:193], s[88:89]
  v_pk_mul_f32 v[18:19], v[194:195], s[88:89]
  v_pk_mul_f32 v[20:21], v[196:197], s[88:89]
  v_pk_mul_f32 v[22:23], v[198:199], s[88:89]
  v_exp_f32 v16, v16
  v_exp_f32 v17, v17
  v_exp_f32 v18, v18
  v_exp_f32 v19, v19
  v_exp_f32 v20, v20
  v_exp_f32 v21, v21
  v_exp_f32 v22, v22
  v_exp_f32 v23, v23
  v_pk_mul_f32 v[192:193], v[192:193], v[200:201]
  v_pk_mul_f32 v[194:195], v[194:195], v[202:203]
  v_pk_mul_f32 v[196:197], v[196:197], v[204:205]
  v_pk_mul_f32 v[198:199], v[198:199], v[206:207]
  v_pk_add_f32 v[16:17], v[16:17], s[90:91]
  v_pk_add_f32 v[18:19], v[18:19], s[90:91]
  v_pk_add_f32 v[20:21], v[20:21], s[90:91]
  v_pk_add_f32 v[22:23], v[22:23], s[90:91]
  v_rcp_f32 v16, v16
  v_rcp_f32 v17, v17
  v_rcp_f32 v18, v18
  v_rcp_f32 v19, v19
  v_rcp_f32 v20, v20
  v_rcp_f32 v21, v21
  v_rcp_f32 v22, v22
  v_rcp_f32 v23, v23
  v_pk_mul_f32 v[192:193], v[192:193], v[16:17]
  v_pk_mul_f32 v[194:195], v[194:195], v[18:19]
  v_pk_mul_f32 v[196:197], v[196:197], v[20:21]
  v_pk_mul_f32 v[198:199], v[198:199], v[22:23]
  v_cvt_pk_bf16_f32 v48, v192, v193
  v_cvt_pk_bf16_f32 v49, v194, v195
  v_cvt_pk_bf16_f32 v50, v196, v197
  v_cvt_pk_bf16_f32 v51, v198, v199
  buffer_store_dwordx4 v[48:51], v83, s[40:43], s3 offen sc1
  s_add_u32 s3, s3, 1024
  v_pk_mul_f32 v[16:17], v[224:225], s[88:89]
  v_pk_mul_f32 v[18:19], v[226:227], s[88:89]
  v_pk_mul_f32 v[20:21], v[228:229], s[88:89]
  v_pk_mul_f32 v[22:23], v[230:231], s[88:89]
  v_exp_f32 v16, v16
  v_exp_f32 v17, v17
  v_exp_f32 v18, v18
  v_exp_f32 v19, v19
  v_exp_f32 v20, v20
  v_exp_f32 v21, v21
  v_exp_f32 v22, v22
  v_exp_f32 v23, v23
  v_pk_mul_f32 v[224:225], v[224:225], v[232:233]
  v_pk_mul_f32 v[226:227], v[226:227], v[234:235]
  v_pk_mul_f32 v[228:229], v[228:229], v[236:237]
  v_pk_mul_f32 v[230:231], v[230:231], v[238:239]
  v_pk_add_f32 v[16:17], v[16:17], s[90:91]
  v_pk_add_f32 v[18:19], v[18:19], s[90:91]
  v_pk_add_f32 v[20:21], v[20:21], s[90:91]
  v_pk_add_f32 v[22:23], v[22:23], s[90:91]
  v_rcp_f32 v16, v16
  v_rcp_f32 v17, v17
  v_rcp_f32 v18, v18
  v_rcp_f32 v19, v19
  v_rcp_f32 v20, v20
  v_rcp_f32 v21, v21
  v_rcp_f32 v22, v22
  v_rcp_f32 v23, v23
  v_pk_mul_f32 v[224:225], v[224:225], v[16:17]
  v_pk_mul_f32 v[226:227], v[226:227], v[18:19]
  v_pk_mul_f32 v[228:229], v[228:229], v[20:21]
  v_pk_mul_f32 v[230:231], v[230:231], v[22:23]
  v_cvt_pk_bf16_f32 v36, v224, v225
  v_cvt_pk_bf16_f32 v37, v226, v227
  v_cvt_pk_bf16_f32 v38, v228, v229
  v_cvt_pk_bf16_f32 v39, v230, v231
  buffer_store_dwordx4 v[36:39], v83, s[40:43], s3 offen sc1
  s_add_u32 s3, s3, 110592
  v_pk_mul_f32 v[16:17], v[112:113], s[88:89]
  v_pk_mul_f32 v[18:19], v[114:115], s[88:89]
  v_pk_mul_f32 v[20:21], v[116:117], s[88:89]
  v_pk_mul_f32 v[22:23], v[118:119], s[88:89]
  v_exp_f32 v16, v16
  v_exp_f32 v17, v17
  v_exp_f32 v18, v18
  v_exp_f32 v19, v19
  v_exp_f32 v20, v20
  v_exp_f32 v21, v21
  v_exp_f32 v22, v22
  v_exp_f32 v23, v23
  v_pk_mul_f32 v[112:113], v[112:113], v[120:121]
  v_pk_mul_f32 v[114:115], v[114:115], v[122:123]
  v_pk_mul_f32 v[116:117], v[116:117], v[124:125]
  v_pk_mul_f32 v[118:119], v[118:119], v[126:127]
  v_pk_add_f32 v[16:17], v[16:17], s[90:91]
  v_pk_add_f32 v[18:19], v[18:19], s[90:91]
  v_pk_add_f32 v[20:21], v[20:21], s[90:91]
  v_pk_add_f32 v[22:23], v[22:23], s[90:91]
  v_rcp_f32 v16, v16
  v_rcp_f32 v17, v17
  v_rcp_f32 v18, v18
  v_rcp_f32 v19, v19
  v_rcp_f32 v20, v20
  v_rcp_f32 v21, v21
  v_rcp_f32 v22, v22
  v_rcp_f32 v23, v23
  v_pk_mul_f32 v[112:113], v[112:113], v[16:17]
  v_pk_mul_f32 v[114:115], v[114:115], v[18:19]
  v_pk_mul_f32 v[116:117], v[116:117], v[20:21]
  v_pk_mul_f32 v[118:119], v[118:119], v[22:23]
  v_cvt_pk_bf16_f32 v40, v112, v113
  v_cvt_pk_bf16_f32 v41, v114, v115
  v_cvt_pk_bf16_f32 v42, v116, v117
  v_cvt_pk_bf16_f32 v43, v118, v119
  buffer_store_dwordx4 v[40:43], v83, s[40:43], s3 offen sc1
  s_add_u32 s3, s3, 1024
  v_pk_mul_f32 v[16:17], v[144:145], s[88:89]
  v_pk_mul_f32 v[18:19], v[146:147], s[88:89]
  v_pk_mul_f32 v[20:21], v[148:149], s[88:89]
  v_pk_mul_f32 v[22:23], v[150:151], s[88:89]
  v_exp_f32 v16, v16
  v_exp_f32 v17, v17
  v_exp_f32 v18, v18
  v_exp_f32 v19, v19
  v_exp_f32 v20, v20
  v_exp_f32 v21, v21
  v_exp_f32 v22, v22
  v_exp_f32 v23, v23
  v_pk_mul_f32 v[144:145], v[144:145], v[152:153]
  v_pk_mul_f32 v[146:147], v[146:147], v[154:155]
  v_pk_mul_f32 v[148:149], v[148:149], v[156:157]
  v_pk_mul_f32 v[150:151], v[150:151], v[158:159]
  v_pk_add_f32 v[16:17], v[16:17], s[90:91]
  v_pk_add_f32 v[18:19], v[18:19], s[90:91]
  v_pk_add_f32 v[20:21], v[20:21], s[90:91]
  v_pk_add_f32 v[22:23], v[22:23], s[90:91]
  v_rcp_f32 v16, v16
  v_rcp_f32 v17, v17
  v_rcp_f32 v18, v18
  v_rcp_f32 v19, v19
  v_rcp_f32 v20, v20
  v_rcp_f32 v21, v21
  v_rcp_f32 v22, v22
  v_rcp_f32 v23, v23
  v_pk_mul_f32 v[144:145], v[144:145], v[16:17]
  v_pk_mul_f32 v[146:147], v[146:147], v[18:19]
  v_pk_mul_f32 v[148:149], v[148:149], v[20:21]
  v_pk_mul_f32 v[150:151], v[150:151], v[22:23]
  v_cvt_pk_bf16_f32 v44, v144, v145
  v_cvt_pk_bf16_f32 v45, v146, v147
  v_cvt_pk_bf16_f32 v46, v148, v149
  v_cvt_pk_bf16_f32 v47, v150, v151
  buffer_store_dwordx4 v[44:47], v83, s[40:43], s3 offen sc1
  s_add_u32 s3, s3, 1024
  v_pk_mul_f32 v[16:17], v[176:177], s[88:89]
  v_pk_mul_f32 v[18:19], v[178:179], s[88:89]
  v_pk_mul_f32 v[20:21], v[180:181], s[88:89]
  v_pk_mul_f32 v[22:23], v[182:183], s[88:89]
  v_exp_f32 v16, v16
  v_exp_f32 v17, v17
  v_exp_f32 v18, v18
  v_exp_f32 v19, v19
  v_exp_f32 v20, v20
  v_exp_f32 v21, v21
  v_exp_f32 v22, v22
  v_exp_f32 v23, v23
  v_pk_mul_f32 v[176:177], v[176:177], v[184:185]
  v_pk_mul_f32 v[178:179], v[178:179], v[186:187]
  v_pk_mul_f32 v[180:181], v[180:181], v[188:189]
  v_pk_mul_f32 v[182:183], v[182:183], v[190:191]
  v_pk_add_f32 v[16:17], v[16:17], s[90:91]
  v_pk_add_f32 v[18:19], v[18:19], s[90:91]
  v_pk_add_f32 v[20:21], v[20:21], s[90:91]
  v_pk_add_f32 v[22:23], v[22:23], s[90:91]
  v_rcp_f32 v16, v16
  v_rcp_f32 v17, v17
  v_rcp_f32 v18, v18
  v_rcp_f32 v19, v19
  v_rcp_f32 v20, v20
  v_rcp_f32 v21, v21
  v_rcp_f32 v22, v22
  v_rcp_f32 v23, v23
  v_pk_mul_f32 v[176:177], v[176:177], v[16:17]
  v_pk_mul_f32 v[178:179], v[178:179], v[18:19]
  v_pk_mul_f32 v[180:181], v[180:181], v[20:21]
  v_pk_mul_f32 v[182:183], v[182:183], v[22:23]
  v_cvt_pk_bf16_f32 v48, v176, v177
  v_cvt_pk_bf16_f32 v49, v178, v179
  v_cvt_pk_bf16_f32 v50, v180, v181
  v_cvt_pk_bf16_f32 v51, v182, v183
  buffer_store_dwordx4 v[48:51], v83, s[40:43], s3 offen sc1
  s_add_u32 s3, s3, 1024
  v_pk_mul_f32 v[16:17], v[208:209], s[88:89]
  v_pk_mul_f32 v[18:19], v[210:211], s[88:89]
  v_pk_mul_f32 v[20:21], v[212:213], s[88:89]
  v_pk_mul_f32 v[22:23], v[214:215], s[88:89]
  v_exp_f32 v16, v16
  v_exp_f32 v17, v17
  v_exp_f32 v18, v18
  v_exp_f32 v19, v19
  v_exp_f32 v20, v20
  v_exp_f32 v21, v21
  v_exp_f32 v22, v22
  v_exp_f32 v23, v23
  v_pk_mul_f32 v[208:209], v[208:209], v[216:217]
  v_pk_mul_f32 v[210:211], v[210:211], v[218:219]
  v_pk_mul_f32 v[212:213], v[212:213], v[220:221]
  v_pk_mul_f32 v[214:215], v[214:215], v[222:223]
  v_pk_add_f32 v[16:17], v[16:17], s[90:91]
  v_pk_add_f32 v[18:19], v[18:19], s[90:91]
  v_pk_add_f32 v[20:21], v[20:21], s[90:91]
  v_pk_add_f32 v[22:23], v[22:23], s[90:91]
  v_rcp_f32 v16, v16
  v_rcp_f32 v17, v17
  v_rcp_f32 v18, v18
  v_rcp_f32 v19, v19
  v_rcp_f32 v20, v20
  v_rcp_f32 v21, v21
  v_rcp_f32 v22, v22
  v_rcp_f32 v23, v23
  v_pk_mul_f32 v[208:209], v[208:209], v[16:17]
  v_pk_mul_f32 v[210:211], v[210:211], v[18:19]
  v_pk_mul_f32 v[212:213], v[212:213], v[20:21]
  v_pk_mul_f32 v[214:215], v[214:215], v[22:23]
  v_cvt_pk_bf16_f32 v36, v208, v209
  v_cvt_pk_bf16_f32 v37, v210, v211
  v_cvt_pk_bf16_f32 v38, v212, v213
  v_cvt_pk_bf16_f32 v39, v214, v215
  buffer_store_dwordx4 v[36:39], v83, s[40:43], s3 offen sc1
  s_add_u32 s3, s3, 1024
  v_pk_mul_f32 v[16:17], v[240:241], s[88:89]
  v_pk_mul_f32 v[18:19], v[242:243], s[88:89]
  v_pk_mul_f32 v[20:21], v[244:245], s[88:89]
  v_pk_mul_f32 v[22:23], v[246:247], s[88:89]
  v_exp_f32 v16, v16
  v_exp_f32 v17, v17
  v_exp_f32 v18, v18
  v_exp_f32 v19, v19
  v_exp_f32 v20, v20
  v_exp_f32 v21, v21
  v_exp_f32 v22, v22
  v_exp_f32 v23, v23
  v_pk_mul_f32 v[240:241], v[240:241], v[248:249]
  v_pk_mul_f32 v[242:243], v[242:243], v[250:251]
  v_pk_mul_f32 v[244:245], v[244:245], v[252:253]
  v_pk_mul_f32 v[246:247], v[246:247], v[254:255]
  v_pk_add_f32 v[16:17], v[16:17], s[90:91]
  v_pk_add_f32 v[18:19], v[18:19], s[90:91]
  v_pk_add_f32 v[20:21], v[20:21], s[90:91]
  v_pk_add_f32 v[22:23], v[22:23], s[90:91]
  v_rcp_f32 v16, v16
  v_rcp_f32 v17, v17
  v_rcp_f32 v18, v18
  v_rcp_f32 v19, v19
  v_rcp_f32 v20, v20
  v_rcp_f32 v21, v21
  v_rcp_f32 v22, v22
  v_rcp_f32 v23, v23
  v_pk_mul_f32 v[240:241], v[240:241], v[16:17]
  v_pk_mul_f32 v[242:243], v[242:243], v[18:19]
  v_pk_mul_f32 v[244:245], v[244:245], v[20:21]
  v_pk_mul_f32 v[246:247], v[246:247], v[22:23]
  v_cvt_pk_bf16_f32 v40, v240, v241
  v_cvt_pk_bf16_f32 v41, v242, v243
  v_cvt_pk_bf16_f32 v42, v244, v245
  v_cvt_pk_bf16_f32 v43, v246, v247
  buffer_store_dwordx4 v[40:43], v83, s[40:43], s3 offen sc1
  s_add_u32 s3, s3, 110592
K1_END:
  s_endpgm
.globl k2_kernel
.p2align 8
.type k2_kernel,@function
k2_kernel:
  s_cmp_ge_u32 s2, 240
  s_cbranch_scc1 K2_END
  s_load_dwordx4 s[4:7], s[0:1], 64
  s_load_dwordx2 s[44:45], s[0:1], 80
  s_cmp_lt_u32 s2, 16
  s_cbranch_scc1 K2_HELPER
  s_sub_u32 s2, s2, 16
  v_lshrrev_b32 v8, 6, v0
  v_and_b32 v0, 63, v0
  v_readfirstlane_b32 s16, v8
  v_lshlrev_b32 v1, 4, v0
  s_and_b32 s3, s2, 7
  s_lshr_b32 s19, s2, 3
  s_mul_i32 s20, s19, 9363
  s_lshr_b32 s20, s20, 16
  s_mul_i32 s18, s20, 7
  s_sub_u32 s18, s19, s18
  s_lshl_b32 s3, s3, 2
  s_add_u32 s17, s3, s20
  s_mov_b32 s33, 0
  s_mul_i32 s19, s16, 28672
  s_lshl_b32 s3, s33, 12
  s_add_u32 s19, s19, s3
  s_mul_i32 s24, s17, 229376
  s_add_u32 s24, s24, s19
  s_add_u32 s24, s24, 2097152
  s_add_u32 s25, s24, 114688
  s_mul_i32 s26, s18, 229376
  s_add_u32 s26, s26, s19
  s_add_u32 s26, s26, 9994240
  s_add_u32 s27, s26, 114688
  s_lshl_b32 s19, s16, 13
  s_add_u32 s28, s19, 9961472
  s_lshl_b32 s29, s17, 16
  s_add_u32 s29, s29, s19
  s_add_u32 s29, s29, 0
  s_add_u32 s30, s29, 32768
  s_lshl_b32 s31, s18, 16
  s_add_u32 s31, s31, s19
  s_add_u32 s31, s31, 11599872
  s_add_u32 s32, s31, 32768
  v_and_b32 v8, 31, v0
  v_lshlrev_b32 v8, 2, v8
  s_lshl_b32 s19, s17, 8
  s_add_u32 s19, s19, 12058624
  s_waitcnt lgkmcnt(0)
  s_mov_b32 s8, s44
  s_and_b32 s9, s45, 0xffff
  s_mov_b32 s10, 0x2000000
  s_mov_b32 s11, 0x00020000
  s_mov_b32 s12, s4
  s_and_b32 s13, s5, 0xffff
  s_mov_b32 s14, 0x1c0000
  s_mov_b32 s15, 0x00020000
  s_mov_b32 s40, s6
  s_and_b32 s41, s7, 0xffff
  s_mov_b32 s42, 0x100
  s_mov_b32 s43, 0x00020000
  buffer_load_dword v2, v8, s[8:11], s19 offen
  buffer_load_dword v4, v8, s[8:11], s19 offen offset:128
  buffer_load_dwordx4 a[0:3], v1, s[8:11], s24 offen offset:0
  buffer_load_dwordx4 a[4:7], v1, s[8:11], s25 offen offset:0
  buffer_load_dwordx4 a[8:11], v1, s[8:11], s26 offen offset:0
  buffer_load_dwordx4 a[12:15], v1, s[8:11], s27 offen offset:0
  buffer_load_dwordx4 a[16:19], v1, s[8:11], s24 offen offset:1024
  buffer_load_dwordx4 a[20:23], v1, s[8:11], s25 offen offset:1024
  buffer_load_dwordx4 a[24:27], v1, s[8:11], s26 offen offset:1024
  buffer_load_dwordx4 a[28:31], v1, s[8:11], s27 offen offset:1024
  buffer_load_dwordx4 a[32:35], v1, s[8:11], s24 offen offset:2048
  buffer_load_dwordx4 a[36:39], v1, s[8:11], s25 offen offset:2048
  buffer_load_dwordx4 a[40:43], v1, s[8:11], s26 offen offset:2048
  buffer_load_dwordx4 a[44:47], v1, s[8:11], s27 offen offset:2048
  buffer_load_dwordx4 a[48:51], v1, s[8:11], s24 offen offset:3072
  buffer_load_dwordx4 a[52:55], v1, s[8:11], s25 offen offset:3072
  buffer_load_dwordx4 a[56:59], v1, s[8:11], s26 offen offset:3072
  buffer_load_dwordx4 a[60:63], v1, s[8:11], s27 offen offset:3072
  s_add_u32 s33, s33, 1
  s_cmp_eq_u32 s33, 7
  s_cselect_b32 s33, 0, s33
  s_mov_b32 s34, 4096
  s_cselect_b32 s34, 0xffffa000, s34
  s_add_u32 s24, s24, s34
  s_add_u32 s25, s25, s34
  s_add_u32 s26, s26, s34
  s_add_u32 s27, s27, s34
  buffer_load_dwordx4 a[64:67], v1, s[8:11], s24 offen offset:0
  buffer_load_dwordx4 a[68:71], v1, s[8:11], s25 offen offset:0
  buffer_load_dwordx4 a[72:75], v1, s[8:11], s26 offen offset:0
  buffer_load_dwordx4 a[76:79], v1, s[8:11], s27 offen offset:0
  buffer_load_dwordx4 a[80:83], v1, s[8:11], s24 offen offset:1024
  buffer_load_dwordx4 a[84:87], v1, s[8:11], s25 offen offset:1024
  buffer_load_dwordx4 a[88:91], v1, s[8:11], s26 offen offset:1024
  buffer_load_dwordx4 a[92:95], v1, s[8:11], s27 offen offset:1024
  buffer_load_dwordx4 a[96:99], v1, s[8:11], s24 offen offset:2048
  buffer_load_dwordx4 a[100:103], v1, s[8:11], s25 offen offset:2048
  buffer_load_dwordx4 a[104:107], v1, s[8:11], s26 offen offset:2048
  buffer_load_dwordx4 a[108:111], v1, s[8:11], s27 offen offset:2048
  buffer_load_dwordx4 a[112:115], v1, s[8:11], s24 offen offset:3072
  buffer_load_dwordx4 a[116:119], v1, s[8:11], s25 offen offset:3072
  buffer_load_dwordx4 a[120:123], v1, s[8:11], s26 offen offset:3072
  buffer_load_dwordx4 a[124:127], v1, s[8:11], s27 offen offset:3072
  s_add_u32 s33, s33, 1
  s_cmp_eq_u32 s33, 7
  s_cselect_b32 s33, 0, s33
  s_mov_b32 s34, 4096
  s_cselect_b32 s34, 0xffffa000, s34
  s_add_u32 s24, s24, s34
  s_add_u32 s25, s25, s34
  s_add_u32 s26, s26, s34
  s_add_u32 s27, s27, s34
  buffer_load_dwordx4 a[128:131], v1, s[8:11], s24 offen offset:0
  buffer_load_dwordx4 a[132:135], v1, s[8:11], s25 offen offset:0
  buffer_load_dwordx4 a[136:139], v1, s[8:11], s26 offen offset:0
  buffer_load_dwordx4 a[140:143], v1, s[8:11], s27 offen offset:0
  buffer_load_dwordx4 a[144:147], v1, s[8:11], s24 offen offset:1024
  buffer_load_dwordx4 a[148:151], v1, s[8:11], s25 offen offset:1024
  buffer_load_dwordx4 a[152:155], v1, s[8:11], s26 offen offset:1024
  buffer_load_dwordx4 a[156:159], v1, s[8:11], s27 offen offset:1024
  s_waitcnt vmcnt(36)
  v_mfma_f32_32x32x16_bf16 v[152:167], a[8:11], a[0:3], 0
  v_mfma_f32_32x32x16_bf16 v[168:183], a[12:15], a[0:3], 0
  v_mfma_f32_32x32x16_bf16 v[184:199], a[8:11], a[4:7], 0
  v_mfma_f32_32x32x16_bf16 v[200:215], a[12:15], a[4:7], 0
  s_waitcnt vmcnt(32)
  v_mfma_f32_32x32x16_bf16 v[152:167], a[24:27], a[16:19], v[152:167]
  buffer_load_dwordx4 a[0:3], v1, s[8:11], s24 offen offset:2048
  v_mfma_f32_32x32x16_bf16 v[168:183], a[28:31], a[16:19], v[168:183]
  buffer_load_dwordx4 a[4:7], v1, s[8:11], s25 offen offset:2048
  v_mfma_f32_32x32x16_bf16 v[184:199], a[24:27], a[20:23], v[184:199]
  buffer_load_dwordx4 a[8:11], v1, s[8:11], s26 offen offset:2048
  v_mfma_f32_32x32x16_bf16 v[200:215], a[28:31], a[20:23], v[200:215]
  buffer_load_dwordx4 a[12:15], v1, s[8:11], s27 offen offset:2048
  s_waitcnt vmcnt(32)
  v_mfma_f32_32x32x16_bf16 v[152:167], a[40:43], a[32:35], v[152:167]
  buffer_load_dwordx4 a[16:19], v1, s[8:11], s24 offen offset:3072
  v_mfma_f32_32x32x16_bf16 v[168:183], a[44:47], a[32:35], v[168:183]
  buffer_load_dwordx4 a[20:23], v1, s[8:11], s25 offen offset:3072
  v_mfma_f32_32x32x16_bf16 v[184:199], a[40:43], a[36:39], v[184:199]
  buffer_load_dwordx4 a[24:27], v1, s[8:11], s26 offen offset:3072
  v_mfma_f32_32x32x16_bf16 v[200:215], a[44:47], a[36:39], v[200:215]
  buffer_load_dwordx4 a[28:31], v1, s[8:11], s27 offen offset:3072
  s_add_u32 s33, s33, 1
  s_cmp_eq_u32 s33, 7
  s_cselect_b32 s33, 0, s33
  s_mov_b32 s34, 4096
  s_cselect_b32 s34, 0xffffa000, s34
  s_add_u32 s24, s24, s34
  s_add_u32 s25, s25, s34
  s_add_u32 s26, s26, s34
  s_add_u32 s27, s27, s34
  s_waitcnt vmcnt(32)
  v_mfma_f32_32x32x16_bf16 v[152:167], a[56:59], a[48:51], v[152:167]
  buffer_load_dwordx4 a[32:35], v1, s[8:11], s24 offen offset:0
  v_mfma_f32_32x32x16_bf16 v[168:183], a[60:63], a[48:51], v[168:183]
  buffer_load_dwordx4 a[36:39], v1, s[8:11], s25 offen offset:0
  v_mfma_f32_32x32x16_bf16 v[184:199], a[56:59], a[52:55], v[184:199]
  buffer_load_dwordx4 a[40:43], v1, s[8:11], s26 offen offset:0
  v_mfma_f32_32x32x16_bf16 v[200:215], a[60:63], a[52:55], v[200:215]
  buffer_load_dwordx4 a[44:47], v1, s[8:11], s27 offen offset:0
  s_waitcnt vmcnt(32)
  v_mfma_f32_32x32x16_bf16 v[152:167], a[72:75], a[64:67], v[152:167]
  buffer_load_dwordx4 a[48:51], v1, s[8:11], s24 offen offset:1024
  v_mfma_f32_32x32x16_bf16 v[168:183], a[76:79], a[64:67], v[168:183]
  buffer_load_dwordx4 a[52:55], v1, s[8:11], s25 offen offset:1024
  v_mfma_f32_32x32x16_bf16 v[184:199], a[72:75], a[68:71], v[184:199]
  buffer_load_dwordx4 a[56:59], v1, s[8:11], s26 offen offset:1024
  v_mfma_f32_32x32x16_bf16 v[200:215], a[76:79], a[68:71], v[200:215]
  buffer_load_dwordx4 a[60:63], v1, s[8:11], s27 offen offset:1024
  s_waitcnt vmcnt(32)
  v_mfma_f32_32x32x16_bf16 v[152:167], a[88:91], a[80:83], v[152:167]
  buffer_load_dwordx4 a[64:67], v1, s[8:11], s24 offen offset:2048
  v_mfma_f32_32x32x16_bf16 v[168:183], a[92:95], a[80:83], v[168:183]
  buffer_load_dwordx4 a[68:71], v1, s[8:11], s25 offen offset:2048
  v_mfma_f32_32x32x16_bf16 v[184:199], a[88:91], a[84:87], v[184:199]
  buffer_load_dwordx4 a[72:75], v1, s[8:11], s26 offen offset:2048
  v_mfma_f32_32x32x16_bf16 v[200:215], a[92:95], a[84:87], v[200:215]
  buffer_load_dwordx4 a[76:79], v1, s[8:11], s27 offen offset:2048
  s_waitcnt vmcnt(32)
  v_mfma_f32_32x32x16_bf16 v[152:167], a[104:107], a[96:99], v[152:167]
  buffer_load_dwordx4 a[80:83], v1, s[8:11], s24 offen offset:3072
  v_mfma_f32_32x32x16_bf16 v[168:183], a[108:111], a[96:99], v[168:183]
  buffer_load_dwordx4 a[84:87], v1, s[8:11], s25 offen offset:3072
  v_mfma_f32_32x32x16_bf16 v[184:199], a[104:107], a[100:103], v[184:199]
  buffer_load_dwordx4 a[88:91], v1, s[8:11], s26 offen offset:3072
  v_mfma_f32_32x32x16_bf16 v[200:215], a[108:111], a[100:103], v[200:215]
  buffer_load_dwordx4 a[92:95], v1, s[8:11], s27 offen offset:3072
  s_add_u32 s33, s33, 1
  s_cmp_eq_u32 s33, 7
  s_cselect_b32 s33, 0, s33
  s_mov_b32 s34, 4096
  s_cselect_b32 s34, 0xffffa000, s34
  s_add_u32 s24, s24, s34
  s_add_u32 s25, s25, s34
  s_add_u32 s26, s26, s34
  s_add_u32 s27, s27, s34
  s_waitcnt vmcnt(32)
  v_mfma_f32_32x32x16_bf16 v[152:167], a[120:123], a[112:115], v[152:167]
  buffer_load_dwordx4 a[96:99], v1, s[8:11], s24 offen offset:0
  v_mfma_f32_32x32x16_bf16 v[168:183], a[124:127], a[112:115], v[168:183]
  buffer_load_dwordx4 a[100:103], v1, s[8:11], s25 offen offset:0
  v_mfma_f32_32x32x16_bf16 v[184:199], a[120:123], a[116:119], v[184:199]
  buffer_load_dwordx4 a[104:107], v1, s[8:11], s26 offen offset:0
  v_mfma_f32_32x32x16_bf16 v[200:215], a[124:127], a[116:119], v[200:215]
  buffer_load_dwordx4 a[108:111], v1, s[8:11], s27 offen offset:0
  s_waitcnt vmcnt(32)
  v_mfma_f32_32x32x16_bf16 v[152:167], a[136:139], a[128:131], v[152:167]
  buffer_load_dwordx4 a[112:115], v1, s[8:11], s24 offen offset:1024
  v_mfma_f32_32x32x16_bf16 v[168:183], a[140:143], a[128:131], v[168:183]
  buffer_load_dwordx4 a[116:119], v1, s[8:11], s25 offen offset:1024
  v_mfma_f32_32x32x16_bf16 v[184:199], a[136:139], a[132:135], v[184:199]
  buffer_load_dwordx4 a[120:123], v1, s[8:11], s26 offen offset:1024
  v_mfma_f32_32x32x16_bf16 v[200:215], a[140:143], a[132:135], v[200:215]
  buffer_load_dwordx4 a[124:127], v1, s[8:11], s27 offen offset:1024
  s_waitcnt vmcnt(32)
  v_mfma_f32_32x32x16_bf16 v[152:167], a[152:155], a[144:147], v[152:167]
  buffer_load_dwordx4 a[128:131], v1, s[8:11], s24 offen offset:2048
  v_mfma_f32_32x32x16_bf16 v[168:183], a[156:159], a[144:147], v[168:183]
  buffer_load_dwordx4 a[132:135], v1, s[8:11], s25 offen offset:2048
  v_mfma_f32_32x32x16_bf16 v[184:199], a[152:155], a[148:151], v[184:199]
  buffer_load_dwordx4 a[136:139], v1, s[8:11], s26 offen offset:2048
  v_mfma_f32_32x32x16_bf16 v[200:215], a[156:159], a[148:151], v[200:215]
  buffer_load_dwordx4 a[140:143], v1, s[8:11], s27 offen offset:2048
  v_mov_b32 v13, 0
  buffer_load_dword v14, v13, s[40:43], 0 offen sc1
  s_waitcnt vmcnt(33)
  v_mfma_f32_32x32x16_bf16 v[152:167], a[8:11], a[0:3], v[152:167]
  buffer_load_dwordx4 a[144:147], v1, s[8:11], s24 offen offset:3072
  v_mfma_f32_32x32x16_bf16 v[168:183], a[12:15], a[0:3], v[168:183]
  buffer_load_dwordx4 a[148:151], v1, s[8:11], s25 offen offset:3072
  v_mfma_f32_32x32x16_bf16 v[184:199], a[8:11], a[4:7], v[184:199]
  buffer_load_dwordx4 a[152:155], v1, s[8:11], s26 offen offset:3072
  v_mfma_f32_32x32x16_bf16 v[200:215], a[12:15], a[4:7], v[200:215]
  buffer_load_dwordx4 a[156:159], v1, s[8:11], s27 offen offset:3072
  s_add_u32 s33, s33, 1
  s_cmp_eq_u32 s33, 7
  s_cselect_b32 s33, 0, s33
  s_mov_b32 s34, 4096
  s_cselect_b32 s34, 0xffffa000, s34
  s_add_u32 s24, s24, s34
  s_add_u32 s25, s25, s34
  s_add_u32 s26, s26, s34
  s_add_u32 s27, s27, s34
  s_waitcnt vmcnt(33)
  v_mfma_f32_32x32x16_bf16 v[152:167], a[24:27], a[16:19], v[152:167]
  buffer_load_dwordx4 a[0:3], v1, s[8:11], s24 offen offset:0
  v_mfma_f32_32x32x16_bf16 v[168:183], a[28:31], a[16:19], v[168:183]
  buffer_load_dwordx4 a[4:7], v1, s[8:11], s25 offen offset:0
  v_mfma_f32_32x32x16_bf16 v[184:199], a[24:27], a[20:23], v[184:199]
  buffer_load_dwordx4 a[8:11], v1, s[8:11], s26 offen offset:0
  v_mfma_f32_32x32x16_bf16 v[200:215], a[28:31], a[20:23], v[200:215]
  buffer_load_dwordx4 a[12:15], v1, s[8:11], s27 offen offset:0
  s_waitcnt vmcnt(33)
  v_mfma_f32_32x32x16_bf16 v[152:167], a[40:43], a[32:35], v[152:167]
  buffer_load_dwordx4 a[16:19], v1, s[8:11], s24 offen offset:1024
  v_mfma_f32_32x32x16_bf16 v[168:183], a[44:47], a[32:35], v[168:183]
  buffer_load_dwordx4 a[20:23], v1, s[8:11], s25 offen offset:1024
  v_mfma_f32_32x32x16_bf16 v[184:199], a[40:43], a[36:39], v[184:199]
  buffer_load_dwordx4 a[24:27], v1, s[8:11], s26 offen offset:1024
  v_mfma_f32_32x32x16_bf16 v[200:215], a[44:47], a[36:39], v[200:215]
  buffer_load_dwordx4 a[28:31], v1, s[8:11], s27 offen offset:1024
  s_waitcnt vmcnt(33)
  v_mfma_f32_32x32x16_bf16 v[152:167], a[56:59], a[48:51], v[152:167]
  buffer_load_dwordx4 a[32:35], v1, s[8:11], s24 offen offset:2048
  v_mfma_f32_32x32x16_bf16 v[168:183], a[60:63], a[48:51], v[168:183]
  buffer_load_dwordx4 a[36:39], v1, s[8:11], s25 offen offset:2048
  v_mfma_f32_32x32x16_bf16 v[184:199], a[56:59], a[52:55], v[184:199]
  buffer_load_dwordx4 a[40:43], v1, s[8:11], s26 offen offset:2048
  v_mfma_f32_32x32x16_bf16 v[200:215], a[60:63], a[52:55], v[200:215]
  buffer_load_dwordx4 a[44:47], v1, s[8:11], s27 offen offset:2048
  s_waitcnt vmcnt(16)
K2_POLL:
  v_readfirstlane_b32 s3, v14
  s_nop 0
  s_cmp_ge_u32 s3, 16
  s_cbranch_scc1 K2_READY
  s_sleep 2
  buffer_load_dword v14, v13, s[40:43], 0 offen sc1
  s_waitcnt vmcnt(0)
  s_branch K2_POLL
K2_READY:
  s_waitcnt vmcnt(33)
  v_mfma_f32_32x32x16_bf16 v[152:167], a[72:75], a[64:67], v[152:167]
  buffer_load_dwordx4 v[80:83], v1, s[8:11], s28 offen offset:0 sc1
  buffer_load_dwordx4 v[84:87], v1, s[8:11], s28 offen offset:1024 sc1
  buffer_load_dwordx4 v[88:91], v1, s[8:11], s29 offen offset:0
  buffer_load_dwordx4 v[92:95], v1, s[8:11], s29 offen offset:1024
  v_mfma_f32_32x32x16_bf16 v[168:183], a[76:79], a[64:67], v[168:183]
  buffer_load_dwordx4 v[96:99], v1, s[8:11], s30 offen offset:0
  buffer_load_dwordx4 v[100:103], v1, s[8:11], s30 offen offset:1024
  buffer_load_dwordx4 v[104:107], v1, s[8:11], s31 offen offset:0
  buffer_load_dwordx4 v[108:111], v1, s[8:11], s31 offen offset:1024
  v_mfma_f32_32x32x16_bf16 v[184:199], a[72:75], a[68:71], v[184:199]
  buffer_load_dwordx4 v[112:115], v1, s[8:11], s32 offen offset:0
  buffer_load_dwordx4 v[116:119], v1, s[8:11], s32 offen offset:1024
  buffer_load_dwordx4 a[48:51], v1, s[8:11], s24 offen offset:3072
  buffer_load_dwordx4 a[52:55], v1, s[8:11], s25 offen offset:3072
  v_mfma_f32_32x32x16_bf16 v[200:215], a[76:79], a[68:71], v[200:215]
  buffer_load_dwordx4 a[56:59], v1, s[8:11], s26 offen offset:3072
  buffer_load_dwordx4 a[60:63], v1, s[8:11], s27 offen offset:3072
  s_add_u32 s33, s33, 1
  s_cmp_eq_u32 s33, 7
  s_cselect_b32 s33, 0, s33
  s_mov_b32 s34, 4096
  s_cselect_b32 s34, 0xffffa000, s34
  s_add_u32 s24, s24, s34
  s_add_u32 s25, s25, s34
  s_add_u32 s26, s26, s34
  s_add_u32 s27, s27, s34
  s_waitcnt vmcnt(43)
  v_mfma_f32_32x32x16_bf16 v[152:167], a[88:91], a[80:83], v[152:167]
  buffer_load_dwordx4 a[64:67], v1, s[8:11], s24 offen offset:0
  v_mfma_f32_32x32x16_bf16 v[168:183], a[92:95], a[80:83], v[168:183]
  buffer_load_dwordx4 a[68:71], v1, s[8:11], s25 offen offset:0
  v_mfma_f32_32x32x16_bf16 v[184:199], a[88:91], a[84:87], v[184:199]
  buffer_load_dwordx4 a[72:75], v1, s[8:11], s26 offen offset:0
  v_mfma_f32_32x32x16_bf16 v[200:215], a[92:95], a[84:87], v[200:215]
  buffer_load_dwordx4 a[76:79], v1, s[8:11], s27 offen offset:0
  s_waitcnt vmcnt(43)
  v_mfma_f32_32x32x16_bf16 v[152:167], a[104:107], a[96:99], v[152:167]
  buffer_load_dwordx4 a[80:83], v1, s[8:11], s24 offen offset:1024
  v_mfma_f32_32x32x16_bf16 v[168:183], a[108:111], a[96:99], v[168:183]
  buffer_load_dwordx4 a[84:87], v1, s[8:11], s25 offen offset:1024
  v_mfma_f32_32x32x16_bf16 v[184:199], a[104:107], a[100:103], v[184:199]
  buffer_load_dwordx4 a[88:91], v1, s[8:11], s26 offen offset:1024
  v_mfma_f32_32x32x16_bf16 v[200:215], a[108:111], a[100:103], v[200:215]
  buffer_load_dwordx4 a[92:95], v1, s[8:11], s27 offen offset:1024
  s_waitcnt vmcnt(12)
  v_mfma_f32_32x32x16_bf16 v[120:135], v[80:83], v[88:91], 0
  buffer_load_dwordx4 a[96:99], v1, s[8:11], s24 offen offset:2048
  v_mfma_f32_32x32x16_bf16 v[120:135], v[84:87], v[92:95], v[120:135]
  buffer_load_dwordx4 a[100:103], v1, s[8:11], s25 offen offset:2048
  s_nop 10
  v_add_f32 v144, 0x358637bd, v132
  v_mov_b32 v145, v144
  s_nop 1
  v_permlane32_swap_b32 v144, v145
  v_rcp_f32 v144, v145
  s_nop 0
  v_mul_f32 v144, v144, v2
  v_mov_b32 v145, v144
  v_pk_mul_f32 v[120:121], v[120:121], v[144:145]
  v_pk_mul_f32 v[122:123], v[122:123], v[144:145]
  v_pk_mul_f32 v[124:125], v[124:125], v[144:145]
  v_pk_mul_f32 v[126:127], v[126:127], v[144:145]
  v_pk_mul_f32 v[128:129], v[128:129], v[144:145]
  v_pk_mul_f32 v[130:131], v[130:131], v[144:145]
  v_pk_mul_f32 v[132:133], v[132:133], v[144:145]
  v_pk_mul_f32 v[134:135], v[134:135], v[144:145]
  v_cvt_pk_bf16_f32 v136, v120, v121
  v_cvt_pk_bf16_f32 v137, v122, v123
  v_cvt_pk_bf16_f32 v138, v124, v125
  v_cvt_pk_bf16_f32 v139, v126, v127
  v_cvt_pk_bf16_f32 v140, v128, v129
  v_cvt_pk_bf16_f32 v141, v130, v131
  v_cvt_pk_bf16_f32 v142, v132, v133
  v_cvt_pk_bf16_f32 v143, v134, v135
  v_mfma_f32_32x32x16_bf16 v[16:31], v[104:107], v[136:139], 0
  buffer_load_dwordx4 a[104:107], v1, s[8:11], s26 offen offset:2048
  v_mfma_f32_32x32x16_bf16 v[32:47], v[112:115], v[136:139], 0
  buffer_load_dwordx4 a[108:111], v1, s[8:11], s27 offen offset:2048
  v_mfma_f32_32x32x16_bf16 v[16:31], v[108:111], v[140:143], v[16:31]
  v_mfma_f32_32x32x16_bf16 v[32:47], v[116:119], v[140:143], v[32:47]
  v_mfma_f32_32x32x16_bf16 v[120:135], v[80:83], v[96:99], 0
  v_mfma_f32_32x32x16_bf16 v[120:135], v[84:87], v[100:103], v[120:135]
  s_nop 11
  v_add_f32 v144, 0x358637bd, v132
  v_mov_b32 v145, v144
  s_nop 1
  v_permlane32_swap_b32 v144, v145
  v_rcp_f32 v144, v145
  s_nop 0
  v_mul_f32 v144, v144, v4
  v_mov_b32 v145, v144
  v_pk_mul_f32 v[120:121], v[120:121], v[144:145]
  v_pk_mul_f32 v[122:123], v[122:123], v[144:145]
  v_pk_mul_f32 v[124:125], v[124:125], v[144:145]
  v_pk_mul_f32 v[126:127], v[126:127], v[144:145]
  v_pk_mul_f32 v[128:129], v[128:129], v[144:145]
  v_pk_mul_f32 v[130:131], v[130:131], v[144:145]
  v_pk_mul_f32 v[132:133], v[132:133], v[144:145]
  v_pk_mul_f32 v[134:135], v[134:135], v[144:145]
  v_cvt_pk_bf16_f32 v136, v120, v121
  v_cvt_pk_bf16_f32 v137, v122, v123
  v_cvt_pk_bf16_f32 v138, v124, v125
  v_cvt_pk_bf16_f32 v139, v126, v127
  v_cvt_pk_bf16_f32 v140, v128, v129
  v_cvt_pk_bf16_f32 v141, v130, v131
  v_cvt_pk_bf16_f32 v142, v132, v133
  v_cvt_pk_bf16_f32 v143, v134, v135
  v_mfma_f32_32x32x16_bf16 v[48:63], v[104:107], v[136:139], 0
  v_mfma_f32_32x32x16_bf16 v[64:79], v[112:115], v[136:139], 0
  v_mfma_f32_32x32x16_bf16 v[48:63], v[108:111], v[140:143], v[48:63]
  v_mfma_f32_32x32x16_bf16 v[64:79], v[116:119], v[140:143], v[64:79]
  s_waitcnt vmcnt(47)
  v_mfma_f32_32x32x16_bf16 v[152:167], a[120:123], a[112:115], v[152:167]
  buffer_load_dwordx4 v[80:83], v1, s[8:11], s28 offen offset:2048 sc1
  buffer_load_dwordx4 v[84:87], v1, s[8:11], s28 offen offset:3072 sc1
  buffer_load_dwordx4 v[88:91], v1, s[8:11], s29 offen offset:2048
  v_mfma_f32_32x32x16_bf16 v[168:183], a[124:127], a[112:115], v[168:183]
  buffer_load_dwordx4 v[92:95], v1, s[8:11], s29 offen offset:3072
  buffer_load_dwordx4 v[96:99], v1, s[8:11], s30 offen offset:2048
  buffer_load_dwordx4 v[100:103], v1, s[8:11], s30 offen offset:3072
  v_mfma_f32_32x32x16_bf16 v[184:199], a[120:123], a[116:119], v[184:199]
  buffer_load_dwordx4 v[104:107], v1, s[8:11], s31 offen offset:2048
  buffer_load_dwordx4 v[108:111], v1, s[8:11], s31 offen offset:3072
  buffer_load_dwordx4 v[112:115], v1, s[8:11], s32 offen offset:2048
  v_mfma_f32_32x32x16_bf16 v[200:215], a[124:127], a[116:119], v[200:215]
  buffer_load_dwordx4 v[116:119], v1, s[8:11], s32 offen offset:3072
  s_add_u32 s28, s28, 4096
  s_add_u32 s29, s29, 4096
  s_add_u32 s30, s30, 4096
  s_add_u32 s31, s31, 4096
  s_add_u32 s32, s32, 4096
  s_waitcnt vmcnt(53)
  v_mfma_f32_32x32x16_bf16 v[152:167], a[136:139], a[128:131], v[152:167]
  buffer_load_dwordx4 a[112:115], v1, s[8:11], s24 offen offset:3072
  v_mfma_f32_32x32x16_bf16 v[168:183], a[140:143], a[128:131], v[168:183]
  buffer_load_dwordx4 a[116:119], v1, s[8:11], s25 offen offset:3072
  v_mfma_f32_32x32x16_bf16 v[184:199], a[136:139], a[132:135], v[184:199]
  buffer_load_dwordx4 a[120:123], v1, s[8:11], s26 offen offset:3072
  v_mfma_f32_32x32x16_bf16 v[200:215], a[140:143], a[132:135], v[200:215]
  buffer_load_dwordx4 a[124:127], v1, s[8:11], s27 offen offset:3072
  s_add_u32 s33, s33, 1
  s_cmp_eq_u32 s33, 7
  s_cselect_b32 s33, 0, s33
  s_mov_b32 s34, 4096
  s_cselect_b32 s34, 0xffffa000, s34
  s_add_u32 s24, s24, s34
  s_add_u32 s25, s25, s34
  s_add_u32 s26, s26, s34
  s_add_u32 s27, s27, s34
  s_waitcnt vmcnt(52)
  v_mfma_f32_32x32x16_bf16 v[152:167], a[152:155], a[144:147], v[152:167]
  v_mfma_f32_32x32x16_bf16 v[168:183], a[156:159], a[144:147], v[168:183]
  v_mfma_f32_32x32x16_bf16 v[184:199], a[152:155], a[148:151], v[184:199]
  v_mfma_f32_32x32x16_bf16 v[200:215], a[156:159], a[148:151], v[200:215]
  s_waitcnt vmcnt(48)
  v_mfma_f32_32x32x16_bf16 v[152:167], a[8:11], a[0:3], v[152:167]
  v_mfma_f32_32x32x16_bf16 v[168:183], a[12:15], a[0:3], v[168:183]
  v_mfma_f32_32x32x16_bf16 v[184:199], a[8:11], a[4:7], v[184:199]
  v_mfma_f32_32x32x16_bf16 v[200:215], a[12:15], a[4:7], v[200:215]
  s_waitcnt vmcnt(4)
  v_mfma_f32_32x32x16_bf16 v[120:135], v[80:83], v[88:91], 0
  v_mfma_f32_32x32x16_bf16 v[120:135], v[84:87], v[92:95], v[120:135]
  s_nop 11
  v_add_f32 v144, 0x358637bd, v132
  v_mov_b32 v145, v144
  s_nop 1
  v_permlane32_swap_b32 v144, v145
  v_rcp_f32 v144, v145
  s_nop 0
  v_mul_f32 v144, v144, v2
  v_mov_b32 v145, v144
  v_pk_mul_f32 v[120:121], v[120:121], v[144:145]
  v_pk_mul_f32 v[122:123], v[122:123], v[144:145]
  v_pk_mul_f32 v[124:125], v[124:125], v[144:145]
  v_pk_mul_f32 v[126:127], v[126:127], v[144:145]
  v_pk_mul_f32 v[128:129], v[128:129], v[144:145]
  v_pk_mul_f32 v[130:131], v[130:131], v[144:145]
  v_pk_mul_f32 v[132:133], v[132:133], v[144:145]
  v_pk_mul_f32 v[134:135], v[134:135], v[144:145]
  v_cvt_pk_bf16_f32 v136, v120, v121
  v_cvt_pk_bf16_f32 v137, v122, v123
  v_cvt_pk_bf16_f32 v138, v124, v125
  v_cvt_pk_bf16_f32 v139, v126, v127
  v_cvt_pk_bf16_f32 v140, v128, v129
  v_cvt_pk_bf16_f32 v141, v130, v131
  v_cvt_pk_bf16_f32 v142, v132, v133
  v_cvt_pk_bf16_f32 v143, v134, v135
  v_mfma_f32_32x32x16_bf16 v[16:31], v[104:107], v[136:139], v[16:31]
  v_mfma_f32_32x32x16_bf16 v[32:47], v[112:115], v[136:139], v[32:47]
  v_mfma_f32_32x32x16_bf16 v[16:31], v[108:111], v[140:143], v[16:31]
  v_mfma_f32_32x32x16_bf16 v[32:47], v[116:119], v[140:143], v[32:47]
  v_mfma_f32_32x32x16_bf16 v[120:135], v[80:83], v[96:99], 0
  v_mfma_f32_32x32x16_bf16 v[120:135], v[84:87], v[100:103], v[120:135]
  s_nop 11
  v_add_f32 v144, 0x358637bd, v132
  v_mov_b32 v145, v144
  s_nop 1
  v_permlane32_swap_b32 v144, v145
  v_rcp_f32 v144, v145
  s_nop 0
  v_mul_f32 v144, v144, v4
  v_mov_b32 v145, v144
  v_pk_mul_f32 v[120:121], v[120:121], v[144:145]
  v_pk_mul_f32 v[122:123], v[122:123], v[144:145]
  v_pk_mul_f32 v[124:125], v[124:125], v[144:145]
  v_pk_mul_f32 v[126:127], v[126:127], v[144:145]
  v_pk_mul_f32 v[128:129], v[128:129], v[144:145]
  v_pk_mul_f32 v[130:131], v[130:131], v[144:145]
  v_pk_mul_f32 v[132:133], v[132:133], v[144:145]
  v_pk_mul_f32 v[134:135], v[134:135], v[144:145]
  v_cvt_pk_bf16_f32 v136, v120, v121
  v_cvt_pk_bf16_f32 v137, v122, v123
  v_cvt_pk_bf16_f32 v138, v124, v125
  v_cvt_pk_bf16_f32 v139, v126, v127
  v_cvt_pk_bf16_f32 v140, v128, v129
  v_cvt_pk_bf16_f32 v141, v130, v131
  v_cvt_pk_bf16_f32 v142, v132, v133
  v_cvt_pk_bf16_f32 v143, v134, v135
  v_mfma_f32_32x32x16_bf16 v[48:63], v[104:107], v[136:139], v[48:63]
  v_mfma_f32_32x32x16_bf16 v[64:79], v[112:115], v[136:139], v[64:79]
  v_mfma_f32_32x32x16_bf16 v[48:63], v[108:111], v[140:143], v[48:63]
  v_mfma_f32_32x32x16_bf16 v[64:79], v[116:119], v[140:143], v[64:79]
  s_waitcnt vmcnt(44)
  v_mfma_f32_32x32x16_bf16 v[152:167], a[24:27], a[16:19], v[152:167]
  buffer_load_dwordx4 v[80:83], v1, s[8:11], s28 offen offset:0 sc1
  buffer_load_dwordx4 v[84:87], v1, s[8:11], s28 offen offset:1024 sc1
  buffer_load_dwordx4 v[88:91], v1, s[8:11], s29 offen offset:0
  v_mfma_f32_32x32x16_bf16 v[168:183], a[28:31], a[16:19], v[168:183]
  buffer_load_dwordx4 v[92:95], v1, s[8:11], s29 offen offset:1024
  buffer_load_dwordx4 v[96:99], v1, s[8:11], s30 offen offset:0
  buffer_load_dwordx4 v[100:103], v1, s[8:11], s30 offen offset:1024
  v_mfma_f32_32x32x16_bf16 v[184:199], a[24:27], a[20:23], v[184:199]
  buffer_load_dwordx4 v[104:107], v1, s[8:11], s31 offen offset:0
  buffer_load_dwordx4 v[108:111], v1, s[8:11], s31 offen offset:1024
  buffer_load_dwordx4 v[112:115], v1, s[8:11], s32 offen offset:0
  v_mfma_f32_32x32x16_bf16 v[200:215], a[28:31], a[20:23], v[200:215]
  buffer_load_dwordx4 v[116:119], v1, s[8:11], s32 offen offset:1024
  s_waitcnt vmcnt(50)
  v_mfma_f32_32x32x16_bf16 v[152:167], a[40:43], a[32:35], v[152:167]
  v_mfma_f32_32x32x16_bf16 v[168:183], a[44:47], a[32:35], v[168:183]
  v_mfma_f32_32x32x16_bf16 v[184:199], a[40:43], a[36:39], v[184:199]
  v_mfma_f32_32x32x16_bf16 v[200:215], a[44:47], a[36:39], v[200:215]
  s_waitcnt vmcnt(36)
  v_mfma_f32_32x32x16_bf16 v[152:167], a[56:59], a[48:51], v[152:167]
  v_mfma_f32_32x32x16_bf16 v[168:183], a[60:63], a[48:51], v[168:183]
  v_mfma_f32_32x32x16_bf16 v[184:199], a[56:59], a[52:55], v[184:199]
  v_mfma_f32_32x32x16_bf16 v[200:215], a[60:63], a[52:55], v[200:215]
  s_waitcnt vmcnt(32)
  v_mfma_f32_32x32x16_bf16 v[152:167], a[72:75], a[64:67], v[152:167]
  v_mfma_f32_32x32x16_bf16 v[168:183], a[76:79], a[64:67], v[168:183]
  v_mfma_f32_32x32x16_bf16 v[184:199], a[72:75], a[68:71], v[184:199]
  v_mfma_f32_32x32x16_bf16 v[200:215], a[76:79], a[68:71], v[200:215]
  s_waitcnt vmcnt(0)
  v_mfma_f32_32x32x16_bf16 v[120:135], v[80:83], v[88:91], 0
  v_mfma_f32_32x32x16_bf16 v[120:135], v[84:87], v[92:95], v[120:135]
  s_nop 11
  v_add_f32 v144, 0x358637bd, v132
  v_mov_b32 v145, v144
  s_nop 1
  v_permlane32_swap_b32 v144, v145
  v_rcp_f32 v144, v145
  s_nop 0
  v_mul_f32 v144, v144, v2
  v_mov_b32 v145, v144
  v_pk_mul_f32 v[120:121], v[120:121], v[144:145]
  v_pk_mul_f32 v[122:123], v[122:123], v[144:145]
  v_pk_mul_f32 v[124:125], v[124:125], v[144:145]
  v_pk_mul_f32 v[126:127], v[126:127], v[144:145]
  v_pk_mul_f32 v[128:129], v[128:129], v[144:145]
  v_pk_mul_f32 v[130:131], v[130:131], v[144:145]
  v_pk_mul_f32 v[132:133], v[132:133], v[144:145]
  v_pk_mul_f32 v[134:135], v[134:135], v[144:145]
  v_cvt_pk_bf16_f32 v136, v120, v121
  v_cvt_pk_bf16_f32 v137, v122, v123
  v_cvt_pk_bf16_f32 v138, v124, v125
  v_cvt_pk_bf16_f32 v139, v126, v127
  v_cvt_pk_bf16_f32 v140, v128, v129
  v_cvt_pk_bf16_f32 v141, v130, v131
  v_cvt_pk_bf16_f32 v142, v132, v133
  v_cvt_pk_bf16_f32 v143, v134, v135
  v_mfma_f32_32x32x16_bf16 v[16:31], v[104:107], v[136:139], v[16:31]
  v_mfma_f32_32x32x16_bf16 v[32:47], v[112:115], v[136:139], v[32:47]
  v_mfma_f32_32x32x16_bf16 v[16:31], v[108:111], v[140:143], v[16:31]
  v_mfma_f32_32x32x16_bf16 v[32:47], v[116:119], v[140:143], v[32:47]
  v_mfma_f32_32x32x16_bf16 v[120:135], v[80:83], v[96:99], 0
  v_mfma_f32_32x32x16_bf16 v[120:135], v[84:87], v[100:103], v[120:135]
  s_nop 11
  v_add_f32 v144, 0x358637bd, v132
  v_mov_b32 v145, v144
  s_nop 1
  v_permlane32_swap_b32 v144, v145
  v_rcp_f32 v144, v145
  s_nop 0
  v_mul_f32 v144, v144, v4
  v_mov_b32 v145, v144
  v_pk_mul_f32 v[120:121], v[120:121], v[144:145]
  v_pk_mul_f32 v[122:123], v[122:123], v[144:145]
  v_pk_mul_f32 v[124:125], v[124:125], v[144:145]
  v_pk_mul_f32 v[126:127], v[126:127], v[144:145]
  v_pk_mul_f32 v[128:129], v[128:129], v[144:145]
  v_pk_mul_f32 v[130:131], v[130:131], v[144:145]
  v_pk_mul_f32 v[132:133], v[132:133], v[144:145]
  v_pk_mul_f32 v[134:135], v[134:135], v[144:145]
  v_cvt_pk_bf16_f32 v136, v120, v121
  v_cvt_pk_bf16_f32 v137, v122, v123
  v_cvt_pk_bf16_f32 v138, v124, v125
  v_cvt_pk_bf16_f32 v139, v126, v127
  v_cvt_pk_bf16_f32 v140, v128, v129
  v_cvt_pk_bf16_f32 v141, v130, v131
  v_cvt_pk_bf16_f32 v142, v132, v133
  v_cvt_pk_bf16_f32 v143, v134, v135
  v_mfma_f32_32x32x16_bf16 v[48:63], v[104:107], v[136:139], v[48:63]
  v_mfma_f32_32x32x16_bf16 v[64:79], v[112:115], v[136:139], v[64:79]
  v_mfma_f32_32x32x16_bf16 v[48:63], v[108:111], v[140:143], v[48:63]
  v_mfma_f32_32x32x16_bf16 v[64:79], v[116:119], v[140:143], v[64:79]
  s_waitcnt vmcnt(28)
  v_mfma_f32_32x32x16_bf16 v[152:167], a[88:91], a[80:83], v[152:167]
  buffer_load_dwordx4 v[80:83], v1, s[8:11], s28 offen offset:2048 sc1
  buffer_load_dwordx4 v[84:87], v1, s[8:11], s28 offen offset:3072 sc1
  buffer_load_dwordx4 v[88:91], v1, s[8:11], s29 offen offset:2048
  v_mfma_f32_32x32x16_bf16 v[168:183], a[92:95], a[80:83], v[168:183]
  buffer_load_dwordx4 v[92:95], v1, s[8:11], s29 offen offset:3072
  buffer_load_dwordx4 v[96:99], v1, s[8:11], s30 offen offset:2048
  buffer_load_dwordx4 v[100:103], v1, s[8:11], s30 offen offset:3072
  v_mfma_f32_32x32x16_bf16 v[184:199], a[88:91], a[84:87], v[184:199]
  buffer_load_dwordx4 v[104:107], v1, s[8:11], s31 offen offset:2048
  buffer_load_dwordx4 v[108:111], v1, s[8:11], s31 offen offset:3072
  buffer_load_dwordx4 v[112:115], v1, s[8:11], s32 offen offset:2048
  v_mfma_f32_32x32x16_bf16 v[200:215], a[92:95], a[84:87], v[200:215]
  buffer_load_dwordx4 v[116:119], v1, s[8:11], s32 offen offset:3072
  s_add_u32 s28, s28, 4096
  s_add_u32 s29, s29, 4096
  s_add_u32 s30, s30, 4096
  s_add_u32 s31, s31, 4096
  s_add_u32 s32, s32, 4096
  s_waitcnt vmcnt(34)
  v_mfma_f32_32x32x16_bf16 v[152:167], a[104:107], a[96:99], v[152:167]
  v_mfma_f32_32x32x16_bf16 v[168:183], a[108:111], a[96:99], v[168:183]
  v_mfma_f32_32x32x16_bf16 v[184:199], a[104:107], a[100:103], v[184:199]
  v_mfma_f32_32x32x16_bf16 v[200:215], a[108:111], a[100:103], v[200:215]
  s_waitcnt vmcnt(20)
  v_mfma_f32_32x32x16_bf16 v[152:167], a[120:123], a[112:115], v[152:167]
  v_mfma_f32_32x32x16_bf16 v[168:183], a[124:127], a[112:115], v[168:183]
  v_mfma_f32_32x32x16_bf16 v[184:199], a[120:123], a[116:119], v[184:199]
  v_mfma_f32_32x32x16_bf16 v[200:215], a[124:127], a[116:119], v[200:215]
  s_waitcnt vmcnt(0)
  v_mfma_f32_32x32x16_bf16 v[120:135], v[80:83], v[88:91], 0
  v_mfma_f32_32x32x16_bf16 v[120:135], v[84:87], v[92:95], v[120:135]
  s_nop 11
  v_add_f32 v144, 0x358637bd, v132
  v_mov_b32 v145, v144
  s_nop 1
  v_permlane32_swap_b32 v144, v145
  v_rcp_f32 v144, v145
  s_nop 0
  v_mul_f32 v144, v144, v2
  v_mov_b32 v145, v144
  v_pk_mul_f32 v[120:121], v[120:121], v[144:145]
  v_pk_mul_f32 v[122:123], v[122:123], v[144:145]
  v_pk_mul_f32 v[124:125], v[124:125], v[144:145]
  v_pk_mul_f32 v[126:127], v[126:127], v[144:145]
  v_pk_mul_f32 v[128:129], v[128:129], v[144:145]
  v_pk_mul_f32 v[130:131], v[130:131], v[144:145]
  v_pk_mul_f32 v[132:133], v[132:133], v[144:145]
  v_pk_mul_f32 v[134:135], v[134:135], v[144:145]
  v_cvt_pk_bf16_f32 v136, v120, v121
  v_cvt_pk_bf16_f32 v137, v122, v123
  v_cvt_pk_bf16_f32 v138, v124, v125
  v_cvt_pk_bf16_f32 v139, v126, v127
  v_cvt_pk_bf16_f32 v140, v128, v129
  v_cvt_pk_bf16_f32 v141, v130, v131
  v_cvt_pk_bf16_f32 v142, v132, v133
  v_cvt_pk_bf16_f32 v143, v134, v135
  v_mfma_f32_32x32x16_bf16 v[16:31], v[104:107], v[136:139], v[16:31]
  v_mfma_f32_32x32x16_bf16 v[32:47], v[112:115], v[136:139], v[32:47]
  v_mfma_f32_32x32x16_bf16 v[16:31], v[108:111], v[140:143], v[16:31]
  v_mfma_f32_32x32x16_bf16 v[32:47], v[116:119], v[140:143], v[32:47]
  v_mfma_f32_32x32x16_bf16 v[120:135], v[80:83], v[96:99], 0
  v_mfma_f32_32x32x16_bf16 v[120:135], v[84:87], v[100:103], v[120:135]
  s_nop 11
  v_add_f32 v144, 0x358637bd, v132
  v_mov_b32 v145, v144
  s_nop 1
  v_permlane32_swap_b32 v144, v145
  v_rcp_f32 v144, v145
  s_nop 0
  v_mul_f32 v144, v144, v4
  v_mov_b32 v145, v144
  v_pk_mul_f32 v[120:121], v[120:121], v[144:145]
  v_pk_mul_f32 v[122:123], v[122:123], v[144:145]
  v_pk_mul_f32 v[124:125], v[124:125], v[144:145]
  v_pk_mul_f32 v[126:127], v[126:127], v[144:145]
  v_pk_mul_f32 v[128:129], v[128:129], v[144:145]
  v_pk_mul_f32 v[130:131], v[130:131], v[144:145]
  v_pk_mul_f32 v[132:133], v[132:133], v[144:145]
  v_pk_mul_f32 v[134:135], v[134:135], v[144:145]
  v_cvt_pk_bf16_f32 v136, v120, v121
  v_cvt_pk_bf16_f32 v137, v122, v123
  v_cvt_pk_bf16_f32 v138, v124, v125
  v_cvt_pk_bf16_f32 v139, v126, v127
  v_cvt_pk_bf16_f32 v140, v128, v129
  v_cvt_pk_bf16_f32 v141, v130, v131
  v_cvt_pk_bf16_f32 v142, v132, v133
  v_cvt_pk_bf16_f32 v143, v134, v135
  v_mfma_f32_32x32x16_bf16 v[48:63], v[104:107], v[136:139], v[48:63]
  v_mfma_f32_32x32x16_bf16 v[64:79], v[112:115], v[136:139], v[64:79]
  v_mfma_f32_32x32x16_bf16 v[48:63], v[108:111], v[140:143], v[48:63]
  v_mfma_f32_32x32x16_bf16 v[64:79], v[116:119], v[140:143], v[64:79]
  v_sub_f32 v6, 1.0, v2
  v_cvt_pk_bf16_f32 v6, v6, v6
  v_and_b32 v7, 0xffff0000, v6
  v_mov_b32 v6, v7
  v_mov_b32 v3, v2
  v_sub_f32 v8, 1.0, v4
  v_cvt_pk_bf16_f32 v8, v8, v8
  v_and_b32 v9, 0xffff0000, v8
  v_mov_b32 v8, v9
  v_mov_b32 v5, v4
  s_lshl_b32 s19, s16, 12
  v_add_u32 v10, s19, v1
  v_pk_fma_f32 v[152:153], v[152:153], v[6:7], v[16:17]
  v_pk_fma_f32 v[154:155], v[154:155], v[6:7], v[18:19]
  v_pk_fma_f32 v[156:157], v[156:157], v[6:7], v[20:21]
  v_pk_fma_f32 v[158:159], v[158:159], v[6:7], v[22:23]
  v_pk_fma_f32 v[160:161], v[160:161], v[6:7], v[24:25]
  v_pk_fma_f32 v[162:163], v[162:163], v[6:7], v[26:27]
  v_pk_fma_f32 v[164:165], v[164:165], v[6:7], v[28:29]
  v_pk_fma_f32 v[166:167], v[166:167], v[6:7], v[30:31]
  ds_write_b128 v10, v[152:155] offset:0
  ds_write_b128 v10, v[156:159] offset:1024
  ds_write_b128 v10, v[160:163] offset:2048
  ds_write_b128 v10, v[164:167] offset:3072
  v_pk_fma_f32 v[168:169], v[168:169], v[6:7], v[32:33]
  v_pk_fma_f32 v[170:171], v[170:171], v[6:7], v[34:35]
  v_pk_fma_f32 v[172:173], v[172:173], v[6:7], v[36:37]
  v_pk_fma_f32 v[174:175], v[174:175], v[6:7], v[38:39]
  v_pk_fma_f32 v[176:177], v[176:177], v[6:7], v[40:41]
  v_pk_fma_f32 v[178:179], v[178:179], v[6:7], v[42:43]
  v_pk_fma_f32 v[180:181], v[180:181], v[6:7], v[44:45]
  v_pk_fma_f32 v[182:183], v[182:183], v[6:7], v[46:47]
  ds_write_b128 v10, v[168:171] offset:16384
  ds_write_b128 v10, v[172:175] offset:17408
  ds_write_b128 v10, v[176:179] offset:18432
  ds_write_b128 v10, v[180:183] offset:19456
  v_pk_fma_f32 v[184:185], v[184:185], v[8:9], v[48:49]
  v_pk_fma_f32 v[186:187], v[186:187], v[8:9], v[50:51]
  v_pk_fma_f32 v[188:189], v[188:189], v[8:9], v[52:53]
  v_pk_fma_f32 v[190:191], v[190:191], v[8:9], v[54:55]
  v_pk_fma_f32 v[192:193], v[192:193], v[8:9], v[56:57]
  v_pk_fma_f32 v[194:195], v[194:195], v[8:9], v[58:59]
  v_pk_fma_f32 v[196:197], v[196:197], v[8:9], v[60:61]
  v_pk_fma_f32 v[198:199], v[198:199], v[8:9], v[62:63]
  ds_write_b128 v10, v[184:187] offset:32768
  ds_write_b128 v10, v[188:191] offset:33792
  ds_write_b128 v10, v[192:195] offset:34816
  ds_write_b128 v10, v[196:199] offset:35840
  v_pk_fma_f32 v[200:201], v[200:201], v[8:9], v[64:65]
  v_pk_fma_f32 v[202:203], v[202:203], v[8:9], v[66:67]
  v_pk_fma_f32 v[204:205], v[204:205], v[8:9], v[68:69]
  v_pk_fma_f32 v[206:207], v[206:207], v[8:9], v[70:71]
  v_pk_fma_f32 v[208:209], v[208:209], v[8:9], v[72:73]
  v_pk_fma_f32 v[210:211], v[210:211], v[8:9], v[74:75]
  v_pk_fma_f32 v[212:213], v[212:213], v[8:9], v[76:77]
  v_pk_fma_f32 v[214:215], v[214:215], v[8:9], v[78:79]
  ds_write_b128 v10, v[200:203] offset:49152
  ds_write_b128 v10, v[204:207] offset:50176
  ds_write_b128 v10, v[208:211] offset:51200
  ds_write_b128 v10, v[212:215] offset:52224
  s_waitcnt lgkmcnt(0)
  s_barrier
  s_lshl_b32 s19, s16, 14
  v_add_u32 v10, s19, v1
  ds_read_b128 v[152:155], v10 offset:0
  ds_read_b128 v[156:159], v10 offset:1024
  ds_read_b128 v[160:163], v10 offset:2048
  ds_read_b128 v[164:167], v10 offset:3072
  ds_read_b128 v[168:171], v10 offset:4096
  ds_read_b128 v[172:175], v10 offset:5120
  ds_read_b128 v[176:179], v10 offset:6144
  ds_read_b128 v[180:183], v10 offset:7168
  ds_read_b128 v[184:187], v10 offset:8192
  ds_read_b128 v[188:191], v10 offset:9216
  ds_read_b128 v[192:195], v10 offset:10240
  ds_read_b128 v[196:199], v10 offset:11264
  ds_read_b128 v[200:203], v10 offset:12288
  ds_read_b128 v[204:207], v10 offset:13312
  ds_read_b128 v[208:211], v10 offset:14336
  ds_read_b128 v[212:215], v10 offset:15360
  s_lshr_b32 s19, s16, 1
  s_lshl_b32 s20, s17, 1
  s_add_u32 s19, s19, s20
  s_mul_i32 s19, s19, 28672
  s_and_b32 s20, s16, 1
  s_lshl_b32 s20, s20, 6
  s_add_u32 s19, s19, s20
  s_lshl_b32 s20, s18, 7
  s_add_u32 s19, s19, s20
  v_and_b32 v9, 31, v0
  v_mul_u32_u24 v9, 896, v9
  v_lshrrev_b32 v10, 5, v0
  v_lshl_add_u32 v9, v10, 5, v9
  s_waitcnt lgkmcnt(0)
  v_pk_add_f32 v[152:153], v[152:153], v[168:169]
  v_pk_add_f32 v[184:185], v[184:185], v[200:201]
  v_pk_add_f32 v[154:155], v[154:155], v[170:171]
  v_pk_add_f32 v[186:187], v[186:187], v[202:203]
  v_pk_add_f32 v[156:157], v[156:157], v[172:173]
  v_pk_add_f32 v[188:189], v[188:189], v[204:205]
  v_pk_add_f32 v[158:159], v[158:159], v[174:175]
  v_pk_add_f32 v[190:191], v[190:191], v[206:207]
  v_pk_add_f32 v[160:161], v[160:161], v[176:177]
  v_pk_add_f32 v[192:193], v[192:193], v[208:209]
  v_pk_add_f32 v[162:163], v[162:163], v[178:179]
  v_pk_add_f32 v[194:195], v[194:195], v[210:211]
  v_pk_add_f32 v[164:165], v[164:165], v[180:181]
  v_pk_add_f32 v[196:197], v[196:197], v[212:213]
  v_pk_add_f32 v[166:167], v[166:167], v[182:183]
  v_pk_add_f32 v[198:199], v[198:199], v[214:215]
  v_pk_add_f32 v[152:153], v[152:153], v[184:185]
  v_pk_add_f32 v[154:155], v[154:155], v[186:187]
  v_pk_add_f32 v[156:157], v[156:157], v[188:189]
  v_pk_add_f32 v[158:159], v[158:159], v[190:191]
  v_pk_add_f32 v[160:161], v[160:161], v[192:193]
  v_pk_add_f32 v[162:163], v[162:163], v[194:195]
  v_pk_add_f32 v[164:165], v[164:165], v[196:197]
  v_pk_add_f32 v[166:167], v[166:167], v[198:199]
  v_cvt_pk_bf16_f32 v80, v152, v153
  v_cvt_pk_bf16_f32 v81, v154, v155
  v_cvt_pk_bf16_f32 v82, v156, v157
  v_cvt_pk_bf16_f32 v83, v158, v159
  v_cvt_pk_bf16_f32 v84, v160, v161
  v_cvt_pk_bf16_f32 v85, v162, v163
  v_cvt_pk_bf16_f32 v86, v164, v165
  v_cvt_pk_bf16_f32 v87, v166, v167
  buffer_store_dwordx4 v[80:83], v9, s[12:15], s19 offen
  buffer_store_dwordx4 v[84:87], v9, s[12:15], s19 offen offset:16
K2_END:
  s_endpgm
K2_HELPER:
  v_lshlrev_b32 v1, 4, v0
  s_lshl_b32 s3, s2, 15
  s_add_u32 s3, s3, 9437184
  s_waitcnt lgkmcnt(0)
  s_mov_b32 s8, s44
  s_and_b32 s9, s45, 0xffff
  s_mov_b32 s10, 0x2000000
  s_mov_b32 s11, 0x00020000
  s_mov_b32 s40, s6
  s_and_b32 s41, s7, 0xffff
  s_mov_b32 s42, 0x100
  s_mov_b32 s43, 0x00020000
  buffer_load_dwordx4 v[4:7], v1, s[8:11], s3 offen
  s_add_u32 s3, s3, 4096
  buffer_load_dwordx4 v[8:11], v1, s[8:11], s3 offen
  s_add_u32 s3, s3, 4096
  buffer_load_dwordx4 v[12:15], v1, s[8:11], s3 offen
  s_add_u32 s3, s3, 4096
  buffer_load_dwordx4 v[16:19], v1, s[8:11], s3 offen
  s_add_u32 s3, s3, 4096
  buffer_load_dwordx4 v[20:23], v1, s[8:11], s3 offen
  s_add_u32 s3, s3, 4096
  buffer_load_dwordx4 v[24:27], v1, s[8:11], s3 offen
  s_add_u32 s3, s3, 4096
  buffer_load_dwordx4 v[28:31], v1, s[8:11], s3 offen
  s_add_u32 s3, s3, 4096
  buffer_load_dwordx4 v[32:35], v1, s[8:11], s3 offen
  s_add_u32 s3, s3, 4096
  v_cmp_le_u32 vcc, 224, v0
  v_lshrrev_b32 v2, 7, v0
  v_lshlrev_b32 v2, 10, v2
  v_and_b32 v3, 63, v0
  v_lshl_add_u32 v2, v3, 4, v2
  v_bfe_u32 v3, v0, 6, 1
  v_lshl_add_u32 v2, v3, 3, v2
  s_lshl_b32 s3, s2, 11
  s_add_u32 s3, s3, 9961472
  s_waitcnt vmcnt(6)
  v_pk_add_f32 v[4:5], v[4:5], v[8:9]
  v_pk_add_f32 v[6:7], v[6:7], v[10:11]
  s_waitcnt vmcnt(5)
  v_pk_add_f32 v[4:5], v[4:5], v[12:13]
  v_pk_add_f32 v[6:7], v[6:7], v[14:15]
  s_waitcnt vmcnt(4)
  v_pk_add_f32 v[4:5], v[4:5], v[16:17]
  v_pk_add_f32 v[6:7], v[6:7], v[18:19]
  s_waitcnt vmcnt(3)
  v_pk_add_f32 v[4:5], v[4:5], v[20:21]
  v_pk_add_f32 v[6:7], v[6:7], v[22:23]
  s_waitcnt vmcnt(2)
  v_pk_add_f32 v[4:5], v[4:5], v[24:25]
  v_pk_add_f32 v[6:7], v[6:7], v[26:27]
  s_waitcnt vmcnt(1)
  v_pk_add_f32 v[4:5], v[4:5], v[28:29]
  v_pk_add_f32 v[6:7], v[6:7], v[30:31]
  s_waitcnt vmcnt(0)
  v_pk_add_f32 v[4:5], v[4:5], v[32:33]
  v_pk_add_f32 v[6:7], v[6:7], v[34:35]
  v_cndmask_b32 v4, v4, 0, vcc
  v_cndmask_b32 v5, v5, 0, vcc
  v_cndmask_b32 v6, v6, 0, vcc
  v_cndmask_b32 v7, v7, 0, vcc
  v_cvt_pk_bf16_f32 v8, v4, v5
  v_cvt_pk_bf16_f32 v9, v6, v7
  buffer_store_dwordx2 v[8:9], v2, s[8:11], s3 offen sc1
  s_waitcnt vmcnt(0)
  s_barrier
  v_cmp_eq_u32 vcc, 0, v0
  s_nop 0
  s_and_saveexec_b64 s[20:21], vcc
  s_cbranch_execz K2_HEND
  v_mov_b32 v10, 1
  v_mov_b32 v11, 0
  buffer_atomic_add v10, v11, s[40:43], 0 offen
K2_HEND:
  s_endpgm
.section .rodata,"a"
.p2align 6
.amdhsa_kernel k1_kernel
  .amdhsa_next_free_vgpr 256
  .amdhsa_next_free_sgpr 102
  .amdhsa_accum_offset 256
  .amdhsa_group_segment_fixed_size 0
  .amdhsa_kernarg_size 88
  .amdhsa_user_sgpr_count 2
  .amdhsa_user_sgpr_kernarg_segment_ptr 1
  .amdhsa_system_sgpr_workgroup_id_x 1
  .amdhsa_float_denorm_mode_32 3
.end_amdhsa_kernel
.p2align 6
.amdhsa_kernel k2_kernel
  .amdhsa_next_free_vgpr 472
  .amdhsa_next_free_sgpr 48
  .amdhsa_accum_offset 216
  .amdhsa_group_segment_fixed_size 0
  .amdhsa_kernarg_size 88
  .amdhsa_user_sgpr_count 2
  .amdhsa_user_sgpr_kernarg_segment_ptr 1
  .amdhsa_system_sgpr_workgroup_id_x 1
  .amdhsa_float_denorm_mode_32 3
.end_amdhsa_kernel
```
